```python
import torch

def _softmax(x, axis=-1):
    return torch.softmax(x, dim=axis)
def _gelu(x):
    return torch.nn.functional.gelu(x, approximate="tanh")
def _silu(x):
    return torch.nn.functional.silu(x)
def _sigmoid(x):
    return torch.sigmoid(x)
def _layernorm(x, axis=-1, eps=1e-5):
    m = x.mean(dim=axis, keepdim=True)
    v = x.var(dim=axis, keepdim=True, unbiased=False)
    return (x - m) / torch.sqrt(v + eps)
def _scatter_add(tgt, idx, src, axis=0):
    return tgt.clone().index_add_(axis, idx, src)
def _segment_sum(src, seg, n):
    out = torch.zeros((n,) + src.shape[1:], dtype=src.dtype)
    return out.index_add_(0, seg, src)
def _pad(x, pw):
    flat = tuple(v for pair in reversed(pw) for v in pair)
    return torch.nn.functional.pad(x, flat)

kernel_name = 'recurrent_scan__ssm_conv_s4d__dense_activation_squared_relu__prompt'

def setup_inputs():

    _w = (lambda a: (lambda t: t.to(torch.bfloat16) if t.is_floating_point() else t)(torch.as_tensor(a)))
    def _A_setup():
        Bsz, L, D, N = 1, 2048, 448, 256
        return {
            "u": _w((lambda *s: torch.randn(*s, dtype=torch.bfloat16) * 0.05)(Bsz, L, D)),
            "log_A_real": _w((lambda *s: torch.randn(*s, dtype=torch.bfloat16) * 3.2)(D, N) * 0.5),
            "A_imag": _w((lambda *s: torch.randn(*s, dtype=torch.bfloat16) * 0.05)(D, N) * 3.14),
            "C_real": _w((lambda *s: torch.randn(*s, dtype=torch.bfloat16) * 0.2)(D, N) / N ** 0.5),
            "C_imag": _w((lambda *s: torch.randn(*s, dtype=torch.bfloat16) * 0.2)(D, N) / N ** 0.5),
            "log_dt": _w((lambda *s: torch.randn(*s, dtype=torch.bfloat16) * 0.05)(D) * 0.5 - 4.0),
            "D_skip": _w((lambda *s: torch.randn(*s, dtype=torch.bfloat16) * 0.05)(D)),
        }
    _A_in = _A_setup()

    def _B_setup():
        B, S, D, F = 1, 2048, 448, 1792
        return {
            "x": _w((lambda *s: torch.randn(*s, dtype=torch.bfloat16) * 0.05)(B, S, D)),
            "w1": _w((lambda *s: torch.randn(*s, dtype=torch.bfloat16) * 0.05)(D, F)),
            "b1": _w((lambda *s: torch.randn(*s, dtype=torch.bfloat16) * 0.4)(F)),
            "w2": _w((lambda *s: torch.randn(*s, dtype=torch.bfloat16) * 0.05)(F, D)),
            "b2": _w((lambda *s: torch.randn(*s, dtype=torch.bfloat16) * 0.8)(D)),
        }
    _B_in = _B_setup()

    return {
        "A_u": _A_in["u"],
        "A_log_A_real": _A_in["log_A_real"],
        "A_A_imag": _A_in["A_imag"],
        "A_C_real": _A_in["C_real"],
        "A_C_imag": _A_in["C_imag"],
        "A_log_dt": _A_in["log_dt"],
        "A_D_skip": _A_in["D_skip"],
        "B_x": _B_in["x"],
        "B_w1": _B_in["w1"],
        "B_b1": _B_in["b1"],
        "B_w2": _B_in["w2"],
        "B_b2": _B_in["b2"],
    }

def reference(A_u, A_log_A_real, A_A_imag, A_C_real, A_C_imag, A_log_dt, A_D_skip, B_x, B_w1, B_b1, B_w2, B_b2):
    def _A_ref(u, log_A_real, A_imag, C_real, C_imag, log_dt, D_skip):
        L = u.shape[1]
        dt = torch.exp(log_dt)
        A = -torch.exp(log_A_real) + 1j * A_imag
        C = (C_real + 1j * C_imag) * dt[:, None]
        pos = (lambda x, dt: x.to(dt))(torch.arange(L), log_dt.dtype)
        P = torch.exp((A * dt[:, None])[:, :, None] * pos[None, None, :])
        K = 2.0 * torch.einsum("dn,dnl->dl", C, P).real
        L2 = 2 * L
        u_t = (lambda x, *d: x.permute(*d))(u, 0, 2, 1)
        Kf = (lambda x, *a, **k: torch.fft.rfft(x.float(), *a, **k))(K, L2)
        Uf = (lambda x, *a, **k: torch.fft.rfft(x.float(), *a, **k))(u_t, L2)
        y = (lambda x, *a, **k: torch.fft.irfft(x, *a, **k).to(torch.bfloat16))(Uf * Kf[None, :, :], L2)[:, :, :L]
        y = (lambda x, *d: x.permute(*d))(y, 0, 2, 1)
        return y + u * D_skip[None, None, :]

    def _B_ref(x, w1, b1, w2, b2):
        h = torch.einsum("bsd,df->bsf", x, w1) + b1
        zero = torch.zeros_like(h)
        r = torch.where(h > zero, h, zero)
        h = r * r
        out = torch.einsum("bsf,fd->bsd", h, w2) + b2
        return out

    x = A_u
    xn = _layernorm(x, axis=-1)
    s = _A_ref(xn, A_log_A_real, A_A_imag, A_C_real, A_C_imag, A_log_dt, A_D_skip)
    g = _silu(_B_ref(xn, B_w1, B_b1, B_w2, B_b2))
    return x + s * g
```

```asm
; @launch kernel=prep_kernel grid=(904,1,1) block=(256,1,1) lds=69696
; @launch kernel=mid_kernel grid=(672,1,1) block=(256,1,1) lds=74240
; @launch kernel=gemm2_kernel grid=(224,1,1) block=(256,1,1) lds=69632
.amdgcn_target "amdgcn-amd-amdhsa--gfx950"
.text
.globl prep_kernel
.p2align 8
.type prep_kernel,@function
prep_kernel:
    s_sub_u32 s3, s2, 0
    s_cmp_ge_u32 s3, 448
    s_cbranch_scc1 L_prep_kernel_r0
    s_load_dwordx8 s[4:11], s[0:1], 8
    s_load_dwordx2 s[12:13], s[0:1], 40
    s_load_dwordx2 s[14:15], s[0:1], 112
    v_and_b32 v1, 63, v0
    v_lshrrev_b32 v2, 6, v0
    s_nop 0
    v_readfirstlane_b32 s44, v2
    s_waitcnt lgkmcnt(0)
    s_mov_b32 s16, s4
    s_and_b32 s17, s5, 0xffff
    s_mov_b32 s18, 229376
    s_mov_b32 s19, 0x00020000
    s_mov_b32 s20, s6
    s_and_b32 s21, s7, 0xffff
    s_mov_b32 s22, 229376
    s_mov_b32 s23, 0x00020000
    s_mov_b32 s24, s8
    s_and_b32 s25, s9, 0xffff
    s_mov_b32 s26, 229376
    s_mov_b32 s27, 0x00020000
    s_mov_b32 s28, s10
    s_and_b32 s29, s11, 0xffff
    s_mov_b32 s30, 229376
    s_mov_b32 s31, 0x00020000
    s_mov_b32 s32, s12
    s_and_b32 s33, s13, 0xffff
    s_mov_b32 s34, 896
    s_mov_b32 s35, 0x00020000
    s_mov_b32 s36, s14
    s_and_b32 s37, s15, 0xffff
    s_mov_b32 s38, 268435456
    s_mov_b32 s39, 0x00020000
    s_lshl_b32 s40, s3, 9
    s_lshl_b32 s41, s3, 1
    v_lshlrev_b32 v3, 3, v1
    v_mov_b32 v2, 0
    buffer_load_dwordx2 v[4:5], v3, s[16:19], s40 offen
    buffer_load_dwordx2 v[6:7], v3, s[20:23], s40 offen
    buffer_load_dwordx2 v[8:9], v3, s[24:27], s40 offen
    buffer_load_dwordx2 v[10:11], v3, s[28:31], s40 offen
    buffer_load_ushort v12, v2, s[32:35], s41 offen
    s_lshl_b32 s45, 1, s44
    s_lshl_b32 s46, 16, s44
    s_lshl_b32 s47, 128, s44
    s_cmp_eq_u32 s44, 0
    s_cselect_b32 s47, 0, s47
    v_cvt_f32_u32 v13, s45
    v_cvt_f32_u32 v14, s46
    v_cvt_f32_u32 v15, s47
    s_mul_i32 s48, s44, 17424
    v_lshlrev_b32 v16, 3, v1
    v_add_u32 v16, s48, v16
    v_and_b32 v17, 15, v1
    v_lshrrev_b32 v18, 4, v1
    v_mul_u32_u24 v17, 528, v17
    v_lshl_add_u32 v17, v18, 4, v17
    v_add_u32 v17, s48, v17
    v_mov_b32 v60, 0
    v_mov_b32 v61, 0
    v_mov_b32 v62, 0
    v_mov_b32 v63, 0
    s_waitcnt vmcnt(0)
    v_lshlrev_b32 v12, 16, v12
    v_mov_b32 v19, 0x3fb8aa3b
    v_mul_f32 v12, v12, v19
    v_exp_f32 v12, v12
    s_nop 0
    v_cvt_pk_bf16_f32 v12, v12, v12
    v_lshlrev_b32 v12, 16, v12
    v_lshlrev_b32 v20, 16, v4
    v_lshlrev_b32 v21, 16, v6
    v_lshlrev_b32 v22, 16, v8
    v_lshlrev_b32 v23, 16, v10
    v_mul_f32 v20, v20, v19
    v_exp_f32 v20, v20
    s_nop 0
    v_cvt_pk_bf16_f32 v20, v20, v20
    v_lshlrev_b32 v20, 16, v20
    v_mul_f32 v20, v20, v12
    v_mul_f32 v20, v20, v19
    v_sub_f32 v20, 0, v20
    v_mul_f32 v21, v21, v12
    v_mul_f32 v21, 0.15915494, v21
    v_mul_f32 v22, v22, v12
    v_mul_f32 v23, v23, v12
    v_add_f32 v22, v22, v22
    v_add_f32 v23, v23, v23
    v_mul_f32 v30, v20, v13
    v_mul_f32 v31, v21, v13
    v_exp_f32 v30, v30
    v_fract_f32 v31, v31
    v_cos_f32 v24, v31
    v_sin_f32 v25, v31
    s_nop 0
    v_mul_f32 v24, v24, v30
    v_mul_f32 v25, v25, v30
    v_mul_f32 v30, v20, v14
    v_mul_f32 v31, v21, v14
    v_exp_f32 v30, v30
    v_fract_f32 v31, v31
    v_cos_f32 v26, v31
    v_sin_f32 v27, v31
    s_nop 0
    v_mul_f32 v26, v26, v30
    v_mul_f32 v27, v27, v30
    v_mul_f32 v30, v20, v15
    v_mul_f32 v31, v21, v15
    v_exp_f32 v30, v30
    v_fract_f32 v31, v31
    v_cos_f32 v28, v31
    v_sin_f32 v29, v31
    s_nop 0
    v_mul_f32 v28, v28, v30
    v_mul_f32 v29, v29, v30
    v_mul_f32 v32, v22, v28
    v_fma_f32 v32, -v23, v29, v32
    v_mul_f32 v33, v22, v29
    v_fma_f32 v33, v23, v28, v33
    v_mov_b32 v34, 1.0
    v_mov_b32 v35, 0
    v_sub_f32 v25, 0, v25
    ds_write_b64 v16, v[32:33] offset:0
    ds_write_b64 v16, v[34:35] offset:8976
    v_mul_f32 v36, v32, v26
    v_mul_f32 v37, v32, v27
    v_mul_f32 v38, v34, v24
    v_mul_f32 v39, v34, v25
    v_fma_f32 v36, -v33, v27, v36
    v_fma_f32 v37, v33, v26, v37
    v_fma_f32 v38, -v35, v25, v38
    v_fma_f32 v39, v35, v24, v39
    ds_write_b64 v16, v[36:37] offset:528
    ds_write_b64 v16, v[38:39] offset:9504
    v_mul_f32 v32, v36, v26
    v_mul_f32 v33, v36, v27
    v_mul_f32 v34, v38, v24
    v_mul_f32 v35, v38, v25
    v_fma_f32 v32, -v37, v27, v32
    v_fma_f32 v33, v37, v26, v33
    v_fma_f32 v34, -v39, v25, v34
    v_fma_f32 v35, v39, v24, v35
    ds_write_b64 v16, v[32:33] offset:1056
    ds_write_b64 v16, v[34:35] offset:10032
    v_mul_f32 v36, v32, v26
    v_mul_f32 v37, v32, v27
    v_mul_f32 v38, v34, v24
    v_mul_f32 v39, v34, v25
    v_fma_f32 v36, -v33, v27, v36
    v_fma_f32 v37, v33, v26, v37
    v_fma_f32 v38, -v35, v25, v38
    v_fma_f32 v39, v35, v24, v39
    ds_write_b64 v16, v[36:37] offset:1584
    ds_write_b64 v16, v[38:39] offset:10560
    v_mul_f32 v32, v36, v26
    v_mul_f32 v33, v36, v27
    v_mul_f32 v34, v38, v24
    v_mul_f32 v35, v38, v25
    v_fma_f32 v32, -v37, v27, v32
    v_fma_f32 v33, v37, v26, v33
    v_fma_f32 v34, -v39, v25, v34
    v_fma_f32 v35, v39, v24, v35
    ds_write_b64 v16, v[32:33] offset:2112
    ds_write_b64 v16, v[34:35] offset:11088
    v_mul_f32 v36, v32, v26
    v_mul_f32 v37, v32, v27
    v_mul_f32 v38, v34, v24
    v_mul_f32 v39, v34, v25
    v_fma_f32 v36, -v33, v27, v36
    v_fma_f32 v37, v33, v26, v37
    v_fma_f32 v38, -v35, v25, v38
    v_fma_f32 v39, v35, v24, v39
    ds_write_b64 v16, v[36:37] offset:2640
    ds_write_b64 v16, v[38:39] offset:11616
    v_mul_f32 v32, v36, v26
    v_mul_f32 v33, v36, v27
    v_mul_f32 v34, v38, v24
    v_mul_f32 v35, v38, v25
    v_fma_f32 v32, -v37, v27, v32
    v_fma_f32 v33, v37, v26, v33
    v_fma_f32 v34, -v39, v25, v34
    v_fma_f32 v35, v39, v24, v35
    ds_write_b64 v16, v[32:33] offset:3168
    ds_write_b64 v16, v[34:35] offset:12144
    v_mul_f32 v36, v32, v26
    v_mul_f32 v37, v32, v27
    v_mul_f32 v38, v34, v24
    v_mul_f32 v39, v34, v25
    v_fma_f32 v36, -v33, v27, v36
    v_fma_f32 v37, v33, v26, v37
    v_fma_f32 v38, -v35, v25, v38
    v_fma_f32 v39, v35, v24, v39
    ds_write_b64 v16, v[36:37] offset:3696
    ds_write_b64 v16, v[38:39] offset:12672
    v_mul_f32 v32, v36, v26
    v_mul_f32 v33, v36, v27
    v_mul_f32 v34, v38, v24
    v_mul_f32 v35, v38, v25
    v_fma_f32 v32, -v37, v27, v32
    v_fma_f32 v33, v37, v26, v33
    v_fma_f32 v34, -v39, v25, v34
    v_fma_f32 v35, v39, v24, v35
    ds_write_b64 v16, v[32:33] offset:4224
    ds_write_b64 v16, v[34:35] offset:13200
    v_mul_f32 v36, v32, v26
    v_mul_f32 v37, v32, v27
    v_mul_f32 v38, v34, v24
    v_mul_f32 v39, v34, v25
    v_fma_f32 v36, -v33, v27, v36
    v_fma_f32 v37, v33, v26, v37
    v_fma_f32 v38, -v35, v25, v38
    v_fma_f32 v39, v35, v24, v39
    ds_write_b64 v16, v[36:37] offset:4752
    ds_write_b64 v16, v[38:39] offset:13728
    v_mul_f32 v32, v36, v26
    v_mul_f32 v33, v36, v27
    v_mul_f32 v34, v38, v24
    v_mul_f32 v35, v38, v25
    v_fma_f32 v32, -v37, v27, v32
    v_fma_f32 v33, v37, v26, v33
    v_fma_f32 v34, -v39, v25, v34
    v_fma_f32 v35, v39, v24, v35
    ds_write_b64 v16, v[32:33] offset:5280
    ds_write_b64 v16, v[34:35] offset:14256
    v_mul_f32 v36, v32, v26
    v_mul_f32 v37, v32, v27
    v_mul_f32 v38, v34, v24
    v_mul_f32 v39, v34, v25
    v_fma_f32 v36, -v33, v27, v36
    v_fma_f32 v37, v33, v26, v37
    v_fma_f32 v38, -v35, v25, v38
    v_fma_f32 v39, v35, v24, v39
    ds_write_b64 v16, v[36:37] offset:5808
    ds_write_b64 v16, v[38:39] offset:14784
    v_mul_f32 v32, v36, v26
    v_mul_f32 v33, v36, v27
    v_mul_f32 v34, v38, v24
    v_mul_f32 v35, v38, v25
    v_fma_f32 v32, -v37, v27, v32
    v_fma_f32 v33, v37, v26, v33
    v_fma_f32 v34, -v39, v25, v34
    v_fma_f32 v35, v39, v24, v35
    ds_write_b64 v16, v[32:33] offset:6336
    ds_write_b64 v16, v[34:35] offset:15312
    v_mul_f32 v36, v32, v26
    v_mul_f32 v37, v32, v27
    v_mul_f32 v38, v34, v24
    v_mul_f32 v39, v34, v25
    v_fma_f32 v36, -v33, v27, v36
    v_fma_f32 v37, v33, v26, v37
    v_fma_f32 v38, -v35, v25, v38
    v_fma_f32 v39, v35, v24, v39
    ds_write_b64 v16, v[36:37] offset:6864
    ds_write_b64 v16, v[38:39] offset:15840
    v_mul_f32 v32, v36, v26
    v_mul_f32 v33, v36, v27
    v_mul_f32 v34, v38, v24
    v_mul_f32 v35, v38, v25
    v_fma_f32 v32, -v37, v27, v32
    v_fma_f32 v33, v37, v26, v33
    v_fma_f32 v34, -v39, v25, v34
    v_fma_f32 v35, v39, v24, v35
    ds_write_b64 v16, v[32:33] offset:7392
    ds_write_b64 v16, v[34:35] offset:16368
    v_mul_f32 v36, v32, v26
    v_mul_f32 v37, v32, v27
    v_mul_f32 v38, v34, v24
    v_mul_f32 v39, v34, v25
    v_fma_f32 v36, -v33, v27, v36
    v_fma_f32 v37, v33, v26, v37
    v_fma_f32 v38, -v35, v25, v38
    v_fma_f32 v39, v35, v24, v39
    ds_write_b64 v16, v[36:37] offset:7920
    ds_write_b64 v16, v[38:39] offset:16896
    v_mul_f32 v32, v36, v26
    v_mul_f32 v33, v36, v27
    v_mul_f32 v34, v38, v24
    v_mul_f32 v35, v38, v25
    v_fma_f32 v32, -v37, v27, v32
    v_fma_f32 v33, v37, v26, v33
    v_fma_f32 v34, -v39, v25, v34
    v_fma_f32 v35, v39, v24, v35
    ds_write_b64 v16, v[32:33] offset:8448
    s_waitcnt lgkmcnt(0)
    ds_read_b128 v[64:67], v17 offset:0
    ds_read_b128 v[68:71], v17 offset:8976
    ds_read_b128 v[72:75], v17 offset:64
    ds_read_b128 v[76:79], v17 offset:9040
    ds_read_b128 v[80:83], v17 offset:128
    ds_read_b128 v[84:87], v17 offset:9104
    ds_read_b128 v[88:91], v17 offset:192
    ds_read_b128 v[92:95], v17 offset:9168
    ds_read_b128 v[96:99], v17 offset:256
    ds_read_b128 v[100:103], v17 offset:9232
    ds_read_b128 v[104:107], v17 offset:320
    ds_read_b128 v[108:111], v17 offset:9296
    ds_read_b128 v[112:115], v17 offset:384
    ds_read_b128 v[116:119], v17 offset:9360
    ds_read_b128 v[120:123], v17 offset:448
    ds_read_b128 v[124:127], v17 offset:9424
    s_waitcnt lgkmcnt(14)
    v_mfma_f32_16x16x4_f32 v[60:63], v64, v68, v[60:63]
    v_mfma_f32_16x16x4_f32 v[60:63], v65, v69, v[60:63]
    v_mfma_f32_16x16x4_f32 v[60:63], v66, v70, v[60:63]
    v_mfma_f32_16x16x4_f32 v[60:63], v67, v71, v[60:63]
    s_waitcnt lgkmcnt(12)
    v_mfma_f32_16x16x4_f32 v[60:63], v72, v76, v[60:63]
    v_mfma_f32_16x16x4_f32 v[60:63], v73, v77, v[60:63]
    v_mfma_f32_16x16x4_f32 v[60:63], v74, v78, v[60:63]
    v_mfma_f32_16x16x4_f32 v[60:63], v75, v79, v[60:63]
    s_waitcnt lgkmcnt(10)
    v_mfma_f32_16x16x4_f32 v[60:63], v80, v84, v[60:63]
    v_mfma_f32_16x16x4_f32 v[60:63], v81, v85, v[60:63]
    v_mfma_f32_16x16x4_f32 v[60:63], v82, v86, v[60:63]
    v_mfma_f32_16x16x4_f32 v[60:63], v83, v87, v[60:63]
    s_waitcnt lgkmcnt(8)
    v_mfma_f32_16x16x4_f32 v[60:63], v88, v92, v[60:63]
    v_mfma_f32_16x16x4_f32 v[60:63], v89, v93, v[60:63]
    v_mfma_f32_16x16x4_f32 v[60:63], v90, v94, v[60:63]
    v_mfma_f32_16x16x4_f32 v[60:63], v91, v95, v[60:63]
    s_waitcnt lgkmcnt(6)
    v_mfma_f32_16x16x4_f32 v[60:63], v96, v100, v[60:63]
    v_mfma_f32_16x16x4_f32 v[60:63], v97, v101, v[60:63]
    v_mfma_f32_16x16x4_f32 v[60:63], v98, v102, v[60:63]
    v_mfma_f32_16x16x4_f32 v[60:63], v99, v103, v[60:63]
    s_waitcnt lgkmcnt(4)
    v_mfma_f32_16x16x4_f32 v[60:63], v104, v108, v[60:63]
    v_mfma_f32_16x16x4_f32 v[60:63], v105, v109, v[60:63]
    v_mfma_f32_16x16x4_f32 v[60:63], v106, v110, v[60:63]
    v_mfma_f32_16x16x4_f32 v[60:63], v107, v111, v[60:63]
    s_waitcnt lgkmcnt(2)
    v_mfma_f32_16x16x4_f32 v[60:63], v112, v116, v[60:63]
    v_mfma_f32_16x16x4_f32 v[60:63], v113, v117, v[60:63]
    v_mfma_f32_16x16x4_f32 v[60:63], v114, v118, v[60:63]
    v_mfma_f32_16x16x4_f32 v[60:63], v115, v119, v[60:63]
    s_waitcnt lgkmcnt(0)
    v_mfma_f32_16x16x4_f32 v[60:63], v120, v124, v[60:63]
    v_mfma_f32_16x16x4_f32 v[60:63], v121, v125, v[60:63]
    v_mfma_f32_16x16x4_f32 v[60:63], v122, v126, v[60:63]
    v_mfma_f32_16x16x4_f32 v[60:63], v123, v127, v[60:63]
    s_nop 7
    v_and_b32 v20, 0xffff0000, v4
    v_and_b32 v21, 0xffff0000, v6
    v_and_b32 v22, 0xffff0000, v8
    v_and_b32 v23, 0xffff0000, v10
    v_mul_f32 v20, v20, v19
    v_exp_f32 v20, v20
    s_nop 0
    v_cvt_pk_bf16_f32 v20, v20, v20
    v_lshlrev_b32 v20, 16, v20
    v_mul_f32 v20, v20, v12
    v_mul_f32 v20, v20, v19
    v_sub_f32 v20, 0, v20
    v_mul_f32 v21, v21, v12
    v_mul_f32 v21, 0.15915494, v21
    v_mul_f32 v22, v22, v12
    v_mul_f32 v23, v23, v12
    v_add_f32 v22, v22, v22
    v_add_f32 v23, v23, v23
    v_mul_f32 v30, v20, v13
    v_mul_f32 v31, v21, v13
    v_exp_f32 v30, v30
    v_fract_f32 v31, v31
    v_cos_f32 v24, v31
    v_sin_f32 v25, v31
    s_nop 0
    v_mul_f32 v24, v24, v30
    v_mul_f32 v25, v25, v30
    v_mul_f32 v30, v20, v14
    v_mul_f32 v31, v21, v14
    v_exp_f32 v30, v30
    v_fract_f32 v31, v31
    v_cos_f32 v26, v31
    v_sin_f32 v27, v31
    s_nop 0
    v_mul_f32 v26, v26, v30
    v_mul_f32 v27, v27, v30
    v_mul_f32 v30, v20, v15
    v_mul_f32 v31, v21, v15
    v_exp_f32 v30, v30
    v_fract_f32 v31, v31
    v_cos_f32 v28, v31
    v_sin_f32 v29, v31
    s_nop 0
    v_mul_f32 v28, v28, v30
    v_mul_f32 v29, v29, v30
    v_mul_f32 v32, v22, v28
    v_fma_f32 v32, -v23, v29, v32
    v_mul_f32 v33, v22, v29
    v_fma_f32 v33, v23, v28, v33
    v_mov_b32 v34, 1.0
    v_mov_b32 v35, 0
    v_sub_f32 v25, 0, v25
    ds_write_b64 v16, v[32:33] offset:0
    ds_write_b64 v16, v[34:35] offset:8976
    v_mul_f32 v36, v32, v26
    v_mul_f32 v37, v32, v27
    v_mul_f32 v38, v34, v24
    v_mul_f32 v39, v34, v25
    v_fma_f32 v36, -v33, v27, v36
    v_fma_f32 v37, v33, v26, v37
    v_fma_f32 v38, -v35, v25, v38
    v_fma_f32 v39, v35, v24, v39
    ds_write_b64 v16, v[36:37] offset:528
    ds_write_b64 v16, v[38:39] offset:9504
    v_mul_f32 v32, v36, v26
    v_mul_f32 v33, v36, v27
    v_mul_f32 v34, v38, v24
    v_mul_f32 v35, v38, v25
    v_fma_f32 v32, -v37, v27, v32
    v_fma_f32 v33, v37, v26, v33
    v_fma_f32 v34, -v39, v25, v34
    v_fma_f32 v35, v39, v24, v35
    ds_write_b64 v16, v[32:33] offset:1056
    ds_write_b64 v16, v[34:35] offset:10032
    v_mul_f32 v36, v32, v26
    v_mul_f32 v37, v32, v27
    v_mul_f32 v38, v34, v24
    v_mul_f32 v39, v34, v25
    v_fma_f32 v36, -v33, v27, v36
    v_fma_f32 v37, v33, v26, v37
    v_fma_f32 v38, -v35, v25, v38
    v_fma_f32 v39, v35, v24, v39
    ds_write_b64 v16, v[36:37] offset:1584
    ds_write_b64 v16, v[38:39] offset:10560
    v_mul_f32 v32, v36, v26
    v_mul_f32 v33, v36, v27
    v_mul_f32 v34, v38, v24
    v_mul_f32 v35, v38, v25
    v_fma_f32 v32, -v37, v27, v32
    v_fma_f32 v33, v37, v26, v33
    v_fma_f32 v34, -v39, v25, v34
    v_fma_f32 v35, v39, v24, v35
    ds_write_b64 v16, v[32:33] offset:2112
    ds_write_b64 v16, v[34:35] offset:11088
    v_mul_f32 v36, v32, v26
    v_mul_f32 v37, v32, v27
    v_mul_f32 v38, v34, v24
    v_mul_f32 v39, v34, v25
    v_fma_f32 v36, -v33, v27, v36
    v_fma_f32 v37, v33, v26, v37
    v_fma_f32 v38, -v35, v25, v38
    v_fma_f32 v39, v35, v24, v39
    ds_write_b64 v16, v[36:37] offset:2640
    ds_write_b64 v16, v[38:39] offset:11616
    v_mul_f32 v32, v36, v26
    v_mul_f32 v33, v36, v27
    v_mul_f32 v34, v38, v24
    v_mul_f32 v35, v38, v25
    v_fma_f32 v32, -v37, v27, v32
    v_fma_f32 v33, v37, v26, v33
    v_fma_f32 v34, -v39, v25, v34
    v_fma_f32 v35, v39, v24, v35
    ds_write_b64 v16, v[32:33] offset:3168
    ds_write_b64 v16, v[34:35] offset:12144
    v_mul_f32 v36, v32, v26
    v_mul_f32 v37, v32, v27
    v_mul_f32 v38, v34, v24
    v_mul_f32 v39, v34, v25
    v_fma_f32 v36, -v33, v27, v36
    v_fma_f32 v37, v33, v26, v37
    v_fma_f32 v38, -v35, v25, v38
    v_fma_f32 v39, v35, v24, v39
    ds_write_b64 v16, v[36:37] offset:3696
    ds_write_b64 v16, v[38:39] offset:12672
    v_mul_f32 v32, v36, v26
    v_mul_f32 v33, v36, v27
    v_mul_f32 v34, v38, v24
    v_mul_f32 v35, v38, v25
    v_fma_f32 v32, -v37, v27, v32
    v_fma_f32 v33, v37, v26, v33
    v_fma_f32 v34, -v39, v25, v34
    v_fma_f32 v35, v39, v24, v35
    ds_write_b64 v16, v[32:33] offset:4224
    ds_write_b64 v16, v[34:35] offset:13200
    v_mul_f32 v36, v32, v26
    v_mul_f32 v37, v32, v27
    v_mul_f32 v38, v34, v24
    v_mul_f32 v39, v34, v25
    v_fma_f32 v36, -v33, v27, v36
    v_fma_f32 v37, v33, v26, v37
    v_fma_f32 v38, -v35, v25, v38
    v_fma_f32 v39, v35, v24, v39
    ds_write_b64 v16, v[36:37] offset:4752
    ds_write_b64 v16, v[38:39] offset:13728
    v_mul_f32 v32, v36, v26
    v_mul_f32 v33, v36, v27
    v_mul_f32 v34, v38, v24
    v_mul_f32 v35, v38, v25
    v_fma_f32 v32, -v37, v27, v32
    v_fma_f32 v33, v37, v26, v33
    v_fma_f32 v34, -v39, v25, v34
    v_fma_f32 v35, v39, v24, v35
    ds_write_b64 v16, v[32:33] offset:5280
    ds_write_b64 v16, v[34:35] offset:14256
    v_mul_f32 v36, v32, v26
    v_mul_f32 v37, v32, v27
    v_mul_f32 v38, v34, v24
    v_mul_f32 v39, v34, v25
    v_fma_f32 v36, -v33, v27, v36
    v_fma_f32 v37, v33, v26, v37
    v_fma_f32 v38, -v35, v25, v38
    v_fma_f32 v39, v35, v24, v39
    ds_write_b64 v16, v[36:37] offset:5808
    ds_write_b64 v16, v[38:39] offset:14784
    v_mul_f32 v32, v36, v26
    v_mul_f32 v33, v36, v27
    v_mul_f32 v34, v38, v24
    v_mul_f32 v35, v38, v25
    v_fma_f32 v32, -v37, v27, v32
    v_fma_f32 v33, v37, v26, v33
    v_fma_f32 v34, -v39, v25, v34
    v_fma_f32 v35, v39, v24, v35
    ds_write_b64 v16, v[32:33] offset:6336
    ds_write_b64 v16, v[34:35] offset:15312
    v_mul_f32 v36, v32, v26
    v_mul_f32 v37, v32, v27
    v_mul_f32 v38, v34, v24
    v_mul_f32 v39, v34, v25
    v_fma_f32 v36, -v33, v27, v36
    v_fma_f32 v37, v33, v26, v37
    v_fma_f32 v38, -v35, v25, v38
    v_fma_f32 v39, v35, v24, v39
    ds_write_b64 v16, v[36:37] offset:6864
    ds_write_b64 v16, v[38:39] offset:15840
    v_mul_f32 v32, v36, v26
    v_mul_f32 v33, v36, v27
    v_mul_f32 v34, v38, v24
    v_mul_f32 v35, v38, v25
    v_fma_f32 v32, -v37, v27, v32
    v_fma_f32 v33, v37, v26, v33
    v_fma_f32 v34, -v39, v25, v34
    v_fma_f32 v35, v39, v24, v35
    ds_write_b64 v16, v[32:33] offset:7392
    ds_write_b64 v16, v[34:35] offset:16368
    v_mul_f32 v36, v32, v26
    v_mul_f32 v37, v32, v27
    v_mul_f32 v38, v34, v24
    v_mul_f32 v39, v34, v25
    v_fma_f32 v36, -v33, v27, v36
    v_fma_f32 v37, v33, v26, v37
    v_fma_f32 v38, -v35, v25, v38
    v_fma_f32 v39, v35, v24, v39
    ds_write_b64 v16, v[36:37] offset:7920
    ds_write_b64 v16, v[38:39] offset:16896
    v_mul_f32 v32, v36, v26
    v_mul_f32 v33, v36, v27
    v_mul_f32 v34, v38, v24
    v_mul_f32 v35, v38, v25
    v_fma_f32 v32, -v37, v27, v32
    v_fma_f32 v33, v37, v26, v33
    v_fma_f32 v34, -v39, v25, v34
    v_fma_f32 v35, v39, v24, v35
    ds_write_b64 v16, v[32:33] offset:8448
    s_waitcnt lgkmcnt(0)
    ds_read_b128 v[64:67], v17 offset:0
    ds_read_b128 v[68:71], v17 offset:8976
    ds_read_b128 v[72:75], v17 offset:64
    ds_read_b128 v[76:79], v17 offset:9040
    ds_read_b128 v[80:83], v17 offset:128
    ds_read_b128 v[84:87], v17 offset:9104
    ds_read_b128 v[88:91], v17 offset:192
    ds_read_b128 v[92:95], v17 offset:9168
    ds_read_b128 v[96:99], v17 offset:256
    ds_read_b128 v[100:103], v17 offset:9232
    ds_read_b128 v[104:107], v17 offset:320
    ds_read_b128 v[108:111], v17 offset:9296
    ds_read_b128 v[112:115], v17 offset:384
    ds_read_b128 v[116:119], v17 offset:9360
    ds_read_b128 v[120:123], v17 offset:448
    ds_read_b128 v[124:127], v17 offset:9424
    s_waitcnt lgkmcnt(14)
    v_mfma_f32_16x16x4_f32 v[60:63], v64, v68, v[60:63]
    v_mfma_f32_16x16x4_f32 v[60:63], v65, v69, v[60:63]
    v_mfma_f32_16x16x4_f32 v[60:63], v66, v70, v[60:63]
    v_mfma_f32_16x16x4_f32 v[60:63], v67, v71, v[60:63]
    s_waitcnt lgkmcnt(12)
    v_mfma_f32_16x16x4_f32 v[60:63], v72, v76, v[60:63]
    v_mfma_f32_16x16x4_f32 v[60:63], v73, v77, v[60:63]
    v_mfma_f32_16x16x4_f32 v[60:63], v74, v78, v[60:63]
    v_mfma_f32_16x16x4_f32 v[60:63], v75, v79, v[60:63]
    s_waitcnt lgkmcnt(10)
    v_mfma_f32_16x16x4_f32 v[60:63], v80, v84, v[60:63]
    v_mfma_f32_16x16x4_f32 v[60:63], v81, v85, v[60:63]
    v_mfma_f32_16x16x4_f32 v[60:63], v82, v86, v[60:63]
    v_mfma_f32_16x16x4_f32 v[60:63], v83, v87, v[60:63]
    s_waitcnt lgkmcnt(8)
    v_mfma_f32_16x16x4_f32 v[60:63], v88, v92, v[60:63]
    v_mfma_f32_16x16x4_f32 v[60:63], v89, v93, v[60:63]
    v_mfma_f32_16x16x4_f32 v[60:63], v90, v94, v[60:63]
    v_mfma_f32_16x16x4_f32 v[60:63], v91, v95, v[60:63]
    s_waitcnt lgkmcnt(6)
    v_mfma_f32_16x16x4_f32 v[60:63], v96, v100, v[60:63]
    v_mfma_f32_16x16x4_f32 v[60:63], v97, v101, v[60:63]
    v_mfma_f32_16x16x4_f32 v[60:63], v98, v102, v[60:63]
    v_mfma_f32_16x16x4_f32 v[60:63], v99, v103, v[60:63]
    s_waitcnt lgkmcnt(4)
    v_mfma_f32_16x16x4_f32 v[60:63], v104, v108, v[60:63]
    v_mfma_f32_16x16x4_f32 v[60:63], v105, v109, v[60:63]
    v_mfma_f32_16x16x4_f32 v[60:63], v106, v110, v[60:63]
    v_mfma_f32_16x16x4_f32 v[60:63], v107, v111, v[60:63]
    s_waitcnt lgkmcnt(2)
    v_mfma_f32_16x16x4_f32 v[60:63], v112, v116, v[60:63]
    v_mfma_f32_16x16x4_f32 v[60:63], v113, v117, v[60:63]
    v_mfma_f32_16x16x4_f32 v[60:63], v114, v118, v[60:63]
    v_mfma_f32_16x16x4_f32 v[60:63], v115, v119, v[60:63]
    s_waitcnt lgkmcnt(0)
    v_mfma_f32_16x16x4_f32 v[60:63], v120, v124, v[60:63]
    v_mfma_f32_16x16x4_f32 v[60:63], v121, v125, v[60:63]
    v_mfma_f32_16x16x4_f32 v[60:63], v122, v126, v[60:63]
    v_mfma_f32_16x16x4_f32 v[60:63], v123, v127, v[60:63]
    s_nop 7
    v_lshlrev_b32 v20, 16, v5
    v_lshlrev_b32 v21, 16, v7
    v_lshlrev_b32 v22, 16, v9
    v_lshlrev_b32 v23, 16, v11
    v_mul_f32 v20, v20, v19
    v_exp_f32 v20, v20
    s_nop 0
    v_cvt_pk_bf16_f32 v20, v20, v20
    v_lshlrev_b32 v20, 16, v20
    v_mul_f32 v20, v20, v12
    v_mul_f32 v20, v20, v19
    v_sub_f32 v20, 0, v20
    v_mul_f32 v21, v21, v12
    v_mul_f32 v21, 0.15915494, v21
    v_mul_f32 v22, v22, v12
    v_mul_f32 v23, v23, v12
    v_add_f32 v22, v22, v22
    v_add_f32 v23, v23, v23
    v_mul_f32 v30, v20, v13
    v_mul_f32 v31, v21, v13
    v_exp_f32 v30, v30
    v_fract_f32 v31, v31
    v_cos_f32 v24, v31
    v_sin_f32 v25, v31
    s_nop 0
    v_mul_f32 v24, v24, v30
    v_mul_f32 v25, v25, v30
    v_mul_f32 v30, v20, v14
    v_mul_f32 v31, v21, v14
    v_exp_f32 v30, v30
    v_fract_f32 v31, v31
    v_cos_f32 v26, v31
    v_sin_f32 v27, v31
    s_nop 0
    v_mul_f32 v26, v26, v30
    v_mul_f32 v27, v27, v30
    v_mul_f32 v30, v20, v15
    v_mul_f32 v31, v21, v15
    v_exp_f32 v30, v30
    v_fract_f32 v31, v31
    v_cos_f32 v28, v31
    v_sin_f32 v29, v31
    s_nop 0
    v_mul_f32 v28, v28, v30
    v_mul_f32 v29, v29, v30
    v_mul_f32 v32, v22, v28
    v_fma_f32 v32, -v23, v29, v32
    v_mul_f32 v33, v22, v29
    v_fma_f32 v33, v23, v28, v33
    v_mov_b32 v34, 1.0
    v_mov_b32 v35, 0
    v_sub_f32 v25, 0, v25
    ds_write_b64 v16, v[32:33] offset:0
    ds_write_b64 v16, v[34:35] offset:8976
    v_mul_f32 v36, v32, v26
    v_mul_f32 v37, v32, v27
    v_mul_f32 v38, v34, v24
    v_mul_f32 v39, v34, v25
    v_fma_f32 v36, -v33, v27, v36
    v_fma_f32 v37, v33, v26, v37
    v_fma_f32 v38, -v35, v25, v38
    v_fma_f32 v39, v35, v24, v39
    ds_write_b64 v16, v[36:37] offset:528
    ds_write_b64 v16, v[38:39] offset:9504
    v_mul_f32 v32, v36, v26
    v_mul_f32 v33, v36, v27
    v_mul_f32 v34, v38, v24
    v_mul_f32 v35, v38, v25
    v_fma_f32 v32, -v37, v27, v32
    v_fma_f32 v33, v37, v26, v33
    v_fma_f32 v34, -v39, v25, v34
    v_fma_f32 v35, v39, v24, v35
    ds_write_b64 v16, v[32:33] offset:1056
    ds_write_b64 v16, v[34:35] offset:10032
    v_mul_f32 v36, v32, v26
    v_mul_f32 v37, v32, v27
    v_mul_f32 v38, v34, v24
    v_mul_f32 v39, v34, v25
    v_fma_f32 v36, -v33, v27, v36
    v_fma_f32 v37, v33, v26, v37
    v_fma_f32 v38, -v35, v25, v38
    v_fma_f32 v39, v35, v24, v39
    ds_write_b64 v16, v[36:37] offset:1584
    ds_write_b64 v16, v[38:39] offset:10560
    v_mul_f32 v32, v36, v26
    v_mul_f32 v33, v36, v27
    v_mul_f32 v34, v38, v24
    v_mul_f32 v35, v38, v25
    v_fma_f32 v32, -v37, v27, v32
    v_fma_f32 v33, v37, v26, v33
    v_fma_f32 v34, -v39, v25, v34
    v_fma_f32 v35, v39, v24, v35
    ds_write_b64 v16, v[32:33] offset:2112
    ds_write_b64 v16, v[34:35] offset:11088
    v_mul_f32 v36, v32, v26
    v_mul_f32 v37, v32, v27
    v_mul_f32 v38, v34, v24
    v_mul_f32 v39, v34, v25
    v_fma_f32 v36, -v33, v27, v36
    v_fma_f32 v37, v33, v26, v37
    v_fma_f32 v38, -v35, v25, v38
    v_fma_f32 v39, v35, v24, v39
    ds_write_b64 v16, v[36:37] offset:2640
    ds_write_b64 v16, v[38:39] offset:11616
    v_mul_f32 v32, v36, v26
    v_mul_f32 v33, v36, v27
    v_mul_f32 v34, v38, v24
    v_mul_f32 v35, v38, v25
    v_fma_f32 v32, -v37, v27, v32
    v_fma_f32 v33, v37, v26, v33
    v_fma_f32 v34, -v39, v25, v34
    v_fma_f32 v35, v39, v24, v35
    ds_write_b64 v16, v[32:33] offset:3168
    ds_write_b64 v16, v[34:35] offset:12144
    v_mul_f32 v36, v32, v26
    v_mul_f32 v37, v32, v27
    v_mul_f32 v38, v34, v24
    v_mul_f32 v39, v34, v25
    v_fma_f32 v36, -v33, v27, v36
    v_fma_f32 v37, v33, v26, v37
    v_fma_f32 v38, -v35, v25, v38
    v_fma_f32 v39, v35, v24, v39
    ds_write_b64 v16, v[36:37] offset:3696
    ds_write_b64 v16, v[38:39] offset:12672
    v_mul_f32 v32, v36, v26
    v_mul_f32 v33, v36, v27
    v_mul_f32 v34, v38, v24
    v_mul_f32 v35, v38, v25
    v_fma_f32 v32, -v37, v27, v32
    v_fma_f32 v33, v37, v26, v33
    v_fma_f32 v34, -v39, v25, v34
    v_fma_f32 v35, v39, v24, v35
    ds_write_b64 v16, v[32:33] offset:4224
    ds_write_b64 v16, v[34:35] offset:13200
    v_mul_f32 v36, v32, v26
    v_mul_f32 v37, v32, v27
    v_mul_f32 v38, v34, v24
    v_mul_f32 v39, v34, v25
    v_fma_f32 v36, -v33, v27, v36
    v_fma_f32 v37, v33, v26, v37
    v_fma_f32 v38, -v35, v25, v38
    v_fma_f32 v39, v35, v24, v39
    ds_write_b64 v16, v[36:37] offset:4752
    ds_write_b64 v16, v[38:39] offset:13728
    v_mul_f32 v32, v36, v26
    v_mul_f32 v33, v36, v27
    v_mul_f32 v34, v38, v24
    v_mul_f32 v35, v38, v25
    v_fma_f32 v32, -v37, v27, v32
    v_fma_f32 v33, v37, v26, v33
    v_fma_f32 v34, -v39, v25, v34
    v_fma_f32 v35, v39, v24, v35
    ds_write_b64 v16, v[32:33] offset:5280
    ds_write_b64 v16, v[34:35] offset:14256
    v_mul_f32 v36, v32, v26
    v_mul_f32 v37, v32, v27
    v_mul_f32 v38, v34, v24
    v_mul_f32 v39, v34, v25
    v_fma_f32 v36, -v33, v27, v36
    v_fma_f32 v37, v33, v26, v37
    v_fma_f32 v38, -v35, v25, v38
    v_fma_f32 v39, v35, v24, v39
    ds_write_b64 v16, v[36:37] offset:5808
    ds_write_b64 v16, v[38:39] offset:14784
    v_mul_f32 v32, v36, v26
    v_mul_f32 v33, v36, v27
    v_mul_f32 v34, v38, v24
    v_mul_f32 v35, v38, v25
    v_fma_f32 v32, -v37, v27, v32
    v_fma_f32 v33, v37, v26, v33
    v_fma_f32 v34, -v39, v25, v34
    v_fma_f32 v35, v39, v24, v35
    ds_write_b64 v16, v[32:33] offset:6336
    ds_write_b64 v16, v[34:35] offset:15312
    v_mul_f32 v36, v32, v26
    v_mul_f32 v37, v32, v27
    v_mul_f32 v38, v34, v24
    v_mul_f32 v39, v34, v25
    v_fma_f32 v36, -v33, v27, v36
    v_fma_f32 v37, v33, v26, v37
    v_fma_f32 v38, -v35, v25, v38
    v_fma_f32 v39, v35, v24, v39
    ds_write_b64 v16, v[36:37] offset:6864
    ds_write_b64 v16, v[38:39] offset:15840
    v_mul_f32 v32, v36, v26
    v_mul_f32 v33, v36, v27
    v_mul_f32 v34, v38, v24
    v_mul_f32 v35, v38, v25
    v_fma_f32 v32, -v37, v27, v32
    v_fma_f32 v33, v37, v26, v33
    v_fma_f32 v34, -v39, v25, v34
    v_fma_f32 v35, v39, v24, v35
    ds_write_b64 v16, v[32:33] offset:7392
    ds_write_b64 v16, v[34:35] offset:16368
    v_mul_f32 v36, v32, v26
    v_mul_f32 v37, v32, v27
    v_mul_f32 v38, v34, v24
    v_mul_f32 v39, v34, v25
    v_fma_f32 v36, -v33, v27, v36
    v_fma_f32 v37, v33, v26, v37
    v_fma_f32 v38, -v35, v25, v38
    v_fma_f32 v39, v35, v24, v39
    ds_write_b64 v16, v[36:37] offset:7920
    ds_write_b64 v16, v[38:39] offset:16896
    v_mul_f32 v32, v36, v26
    v_mul_f32 v33, v36, v27
    v_mul_f32 v34, v38, v24
    v_mul_f32 v35, v38, v25
    v_fma_f32 v32, -v37, v27, v32
    v_fma_f32 v33, v37, v26, v33
    v_fma_f32 v34, -v39, v25, v34
    v_fma_f32 v35, v39, v24, v35
    ds_write_b64 v16, v[32:33] offset:8448
    s_waitcnt lgkmcnt(0)
    ds_read_b128 v[64:67], v17 offset:0
    ds_read_b128 v[68:71], v17 offset:8976
    ds_read_b128 v[72:75], v17 offset:64
    ds_read_b128 v[76:79], v17 offset:9040
    ds_read_b128 v[80:83], v17 offset:128
    ds_read_b128 v[84:87], v17 offset:9104
    ds_read_b128 v[88:91], v17 offset:192
    ds_read_b128 v[92:95], v17 offset:9168
    ds_read_b128 v[96:99], v17 offset:256
    ds_read_b128 v[100:103], v17 offset:9232
    ds_read_b128 v[104:107], v17 offset:320
    ds_read_b128 v[108:111], v17 offset:9296
    ds_read_b128 v[112:115], v17 offset:384
    ds_read_b128 v[116:119], v17 offset:9360
    ds_read_b128 v[120:123], v17 offset:448
    ds_read_b128 v[124:127], v17 offset:9424
    s_waitcnt lgkmcnt(14)
    v_mfma_f32_16x16x4_f32 v[60:63], v64, v68, v[60:63]
    v_mfma_f32_16x16x4_f32 v[60:63], v65, v69, v[60:63]
    v_mfma_f32_16x16x4_f32 v[60:63], v66, v70, v[60:63]
    v_mfma_f32_16x16x4_f32 v[60:63], v67, v71, v[60:63]
    s_waitcnt lgkmcnt(12)
    v_mfma_f32_16x16x4_f32 v[60:63], v72, v76, v[60:63]
    v_mfma_f32_16x16x4_f32 v[60:63], v73, v77, v[60:63]
    v_mfma_f32_16x16x4_f32 v[60:63], v74, v78, v[60:63]
    v_mfma_f32_16x16x4_f32 v[60:63], v75, v79, v[60:63]
    s_waitcnt lgkmcnt(10)
    v_mfma_f32_16x16x4_f32 v[60:63], v80, v84, v[60:63]
    v_mfma_f32_16x16x4_f32 v[60:63], v81, v85, v[60:63]
    v_mfma_f32_16x16x4_f32 v[60:63], v82, v86, v[60:63]
    v_mfma_f32_16x16x4_f32 v[60:63], v83, v87, v[60:63]
    s_waitcnt lgkmcnt(8)
    v_mfma_f32_16x16x4_f32 v[60:63], v88, v92, v[60:63]
    v_mfma_f32_16x16x4_f32 v[60:63], v89, v93, v[60:63]
    v_mfma_f32_16x16x4_f32 v[60:63], v90, v94, v[60:63]
    v_mfma_f32_16x16x4_f32 v[60:63], v91, v95, v[60:63]
    s_waitcnt lgkmcnt(6)
    v_mfma_f32_16x16x4_f32 v[60:63], v96, v100, v[60:63]
    v_mfma_f32_16x16x4_f32 v[60:63], v97, v101, v[60:63]
    v_mfma_f32_16x16x4_f32 v[60:63], v98, v102, v[60:63]
    v_mfma_f32_16x16x4_f32 v[60:63], v99, v103, v[60:63]
    s_waitcnt lgkmcnt(4)
    v_mfma_f32_16x16x4_f32 v[60:63], v104, v108, v[60:63]
    v_mfma_f32_16x16x4_f32 v[60:63], v105, v109, v[60:63]
    v_mfma_f32_16x16x4_f32 v[60:63], v106, v110, v[60:63]
    v_mfma_f32_16x16x4_f32 v[60:63], v107, v111, v[60:63]
    s_waitcnt lgkmcnt(2)
    v_mfma_f32_16x16x4_f32 v[60:63], v112, v116, v[60:63]
    v_mfma_f32_16x16x4_f32 v[60:63], v113, v117, v[60:63]
    v_mfma_f32_16x16x4_f32 v[60:63], v114, v118, v[60:63]
    v_mfma_f32_16x16x4_f32 v[60:63], v115, v119, v[60:63]
    s_waitcnt lgkmcnt(0)
    v_mfma_f32_16x16x4_f32 v[60:63], v120, v124, v[60:63]
    v_mfma_f32_16x16x4_f32 v[60:63], v121, v125, v[60:63]
    v_mfma_f32_16x16x4_f32 v[60:63], v122, v126, v[60:63]
    v_mfma_f32_16x16x4_f32 v[60:63], v123, v127, v[60:63]
    s_nop 7
    v_and_b32 v20, 0xffff0000, v5
    v_and_b32 v21, 0xffff0000, v7
    v_and_b32 v22, 0xffff0000, v9
    v_and_b32 v23, 0xffff0000, v11
    v_mul_f32 v20, v20, v19
    v_exp_f32 v20, v20
    s_nop 0
    v_cvt_pk_bf16_f32 v20, v20, v20
    v_lshlrev_b32 v20, 16, v20
    v_mul_f32 v20, v20, v12
    v_mul_f32 v20, v20, v19
    v_sub_f32 v20, 0, v20
    v_mul_f32 v21, v21, v12
    v_mul_f32 v21, 0.15915494, v21
    v_mul_f32 v22, v22, v12
    v_mul_f32 v23, v23, v12
    v_add_f32 v22, v22, v22
    v_add_f32 v23, v23, v23
    v_mul_f32 v30, v20, v13
    v_mul_f32 v31, v21, v13
    v_exp_f32 v30, v30
    v_fract_f32 v31, v31
    v_cos_f32 v24, v31
    v_sin_f32 v25, v31
    s_nop 0
    v_mul_f32 v24, v24, v30
    v_mul_f32 v25, v25, v30
    v_mul_f32 v30, v20, v14
    v_mul_f32 v31, v21, v14
    v_exp_f32 v30, v30
    v_fract_f32 v31, v31
    v_cos_f32 v26, v31
    v_sin_f32 v27, v31
    s_nop 0
    v_mul_f32 v26, v26, v30
    v_mul_f32 v27, v27, v30
    v_mul_f32 v30, v20, v15
    v_mul_f32 v31, v21, v15
    v_exp_f32 v30, v30
    v_fract_f32 v31, v31
    v_cos_f32 v28, v31
    v_sin_f32 v29, v31
    s_nop 0
    v_mul_f32 v28, v28, v30
    v_mul_f32 v29, v29, v30
    v_mul_f32 v32, v22, v28
    v_fma_f32 v32, -v23, v29, v32
    v_mul_f32 v33, v22, v29
    v_fma_f32 v33, v23, v28, v33
    v_mov_b32 v34, 1.0
    v_mov_b32 v35, 0
    v_sub_f32 v25, 0, v25
    ds_write_b64 v16, v[32:33] offset:0
    ds_write_b64 v16, v[34:35] offset:8976
    v_mul_f32 v36, v32, v26
    v_mul_f32 v37, v32, v27
    v_mul_f32 v38, v34, v24
    v_mul_f32 v39, v34, v25
    v_fma_f32 v36, -v33, v27, v36
    v_fma_f32 v37, v33, v26, v37
    v_fma_f32 v38, -v35, v25, v38
    v_fma_f32 v39, v35, v24, v39
    ds_write_b64 v16, v[36:37] offset:528
    ds_write_b64 v16, v[38:39] offset:9504
    v_mul_f32 v32, v36, v26
    v_mul_f32 v33, v36, v27
    v_mul_f32 v34, v38, v24
    v_mul_f32 v35, v38, v25
    v_fma_f32 v32, -v37, v27, v32
    v_fma_f32 v33, v37, v26, v33
    v_fma_f32 v34, -v39, v25, v34
    v_fma_f32 v35, v39, v24, v35
    ds_write_b64 v16, v[32:33] offset:1056
    ds_write_b64 v16, v[34:35] offset:10032
    v_mul_f32 v36, v32, v26
    v_mul_f32 v37, v32, v27
    v_mul_f32 v38, v34, v24
    v_mul_f32 v39, v34, v25
    v_fma_f32 v36, -v33, v27, v36
    v_fma_f32 v37, v33, v26, v37
    v_fma_f32 v38, -v35, v25, v38
    v_fma_f32 v39, v35, v24, v39
    ds_write_b64 v16, v[36:37] offset:1584
    ds_write_b64 v16, v[38:39] offset:10560
    v_mul_f32 v32, v36, v26
    v_mul_f32 v33, v36, v27
    v_mul_f32 v34, v38, v24
    v_mul_f32 v35, v38, v25
    v_fma_f32 v32, -v37, v27, v32
    v_fma_f32 v33, v37, v26, v33
    v_fma_f32 v34, -v39, v25, v34
    v_fma_f32 v35, v39, v24, v35
    ds_write_b64 v16, v[32:33] offset:2112
    ds_write_b64 v16, v[34:35] offset:11088
    v_mul_f32 v36, v32, v26
    v_mul_f32 v37, v32, v27
    v_mul_f32 v38, v34, v24
    v_mul_f32 v39, v34, v25
    v_fma_f32 v36, -v33, v27, v36
    v_fma_f32 v37, v33, v26, v37
    v_fma_f32 v38, -v35, v25, v38
    v_fma_f32 v39, v35, v24, v39
    ds_write_b64 v16, v[36:37] offset:2640
    ds_write_b64 v16, v[38:39] offset:11616
    v_mul_f32 v32, v36, v26
    v_mul_f32 v33, v36, v27
    v_mul_f32 v34, v38, v24
    v_mul_f32 v35, v38, v25
    v_fma_f32 v32, -v37, v27, v32
    v_fma_f32 v33, v37, v26, v33
    v_fma_f32 v34, -v39, v25, v34
    v_fma_f32 v35, v39, v24, v35
    ds_write_b64 v16, v[32:33] offset:3168
    ds_write_b64 v16, v[34:35] offset:12144
    v_mul_f32 v36, v32, v26
    v_mul_f32 v37, v32, v27
    v_mul_f32 v38, v34, v24
    v_mul_f32 v39, v34, v25
    v_fma_f32 v36, -v33, v27, v36
    v_fma_f32 v37, v33, v26, v37
    v_fma_f32 v38, -v35, v25, v38
    v_fma_f32 v39, v35, v24, v39
    ds_write_b64 v16, v[36:37] offset:3696
    ds_write_b64 v16, v[38:39] offset:12672
    v_mul_f32 v32, v36, v26
    v_mul_f32 v33, v36, v27
    v_mul_f32 v34, v38, v24
    v_mul_f32 v35, v38, v25
    v_fma_f32 v32, -v37, v27, v32
    v_fma_f32 v33, v37, v26, v33
    v_fma_f32 v34, -v39, v25, v34
    v_fma_f32 v35, v39, v24, v35
    ds_write_b64 v16, v[32:33] offset:4224
    ds_write_b64 v16, v[34:35] offset:13200
    v_mul_f32 v36, v32, v26
    v_mul_f32 v37, v32, v27
    v_mul_f32 v38, v34, v24
    v_mul_f32 v39, v34, v25
    v_fma_f32 v36, -v33, v27, v36
    v_fma_f32 v37, v33, v26, v37
    v_fma_f32 v38, -v35, v25, v38
    v_fma_f32 v39, v35, v24, v39
    ds_write_b64 v16, v[36:37] offset:4752
    ds_write_b64 v16, v[38:39] offset:13728
    v_mul_f32 v32, v36, v26
    v_mul_f32 v33, v36, v27
    v_mul_f32 v34, v38, v24
    v_mul_f32 v35, v38, v25
    v_fma_f32 v32, -v37, v27, v32
    v_fma_f32 v33, v37, v26, v33
    v_fma_f32 v34, -v39, v25, v34
    v_fma_f32 v35, v39, v24, v35
    ds_write_b64 v16, v[32:33] offset:5280
    ds_write_b64 v16, v[34:35] offset:14256
    v_mul_f32 v36, v32, v26
    v_mul_f32 v37, v32, v27
    v_mul_f32 v38, v34, v24
    v_mul_f32 v39, v34, v25
    v_fma_f32 v36, -v33, v27, v36
    v_fma_f32 v37, v33, v26, v37
    v_fma_f32 v38, -v35, v25, v38
    v_fma_f32 v39, v35, v24, v39
    ds_write_b64 v16, v[36:37] offset:5808
    ds_write_b64 v16, v[38:39] offset:14784
    v_mul_f32 v32, v36, v26
    v_mul_f32 v33, v36, v27
    v_mul_f32 v34, v38, v24
    v_mul_f32 v35, v38, v25
    v_fma_f32 v32, -v37, v27, v32
    v_fma_f32 v33, v37, v26, v33
    v_fma_f32 v34, -v39, v25, v34
    v_fma_f32 v35, v39, v24, v35
    ds_write_b64 v16, v[32:33] offset:6336
    ds_write_b64 v16, v[34:35] offset:15312
    v_mul_f32 v36, v32, v26
    v_mul_f32 v37, v32, v27
    v_mul_f32 v38, v34, v24
    v_mul_f32 v39, v34, v25
    v_fma_f32 v36, -v33, v27, v36
    v_fma_f32 v37, v33, v26, v37
    v_fma_f32 v38, -v35, v25, v38
    v_fma_f32 v39, v35, v24, v39
    ds_write_b64 v16, v[36:37] offset:6864
    ds_write_b64 v16, v[38:39] offset:15840
    v_mul_f32 v32, v36, v26
    v_mul_f32 v33, v36, v27
    v_mul_f32 v34, v38, v24
    v_mul_f32 v35, v38, v25
    v_fma_f32 v32, -v37, v27, v32
    v_fma_f32 v33, v37, v26, v33
    v_fma_f32 v34, -v39, v25, v34
    v_fma_f32 v35, v39, v24, v35
    ds_write_b64 v16, v[32:33] offset:7392
    ds_write_b64 v16, v[34:35] offset:16368
    v_mul_f32 v36, v32, v26
    v_mul_f32 v37, v32, v27
    v_mul_f32 v38, v34, v24
    v_mul_f32 v39, v34, v25
    v_fma_f32 v36, -v33, v27, v36
    v_fma_f32 v37, v33, v26, v37
    v_fma_f32 v38, -v35, v25, v38
    v_fma_f32 v39, v35, v24, v39
    ds_write_b64 v16, v[36:37] offset:7920
    ds_write_b64 v16, v[38:39] offset:16896
    v_mul_f32 v32, v36, v26
    v_mul_f32 v33, v36, v27
    v_mul_f32 v34, v38, v24
    v_mul_f32 v35, v38, v25
    v_fma_f32 v32, -v37, v27, v32
    v_fma_f32 v33, v37, v26, v33
    v_fma_f32 v34, -v39, v25, v34
    v_fma_f32 v35, v39, v24, v35
    ds_write_b64 v16, v[32:33] offset:8448
    s_waitcnt lgkmcnt(0)
    ds_read_b128 v[64:67], v17 offset:0
    ds_read_b128 v[68:71], v17 offset:8976
    ds_read_b128 v[72:75], v17 offset:64
    ds_read_b128 v[76:79], v17 offset:9040
    ds_read_b128 v[80:83], v17 offset:128
    ds_read_b128 v[84:87], v17 offset:9104
    ds_read_b128 v[88:91], v17 offset:192
    ds_read_b128 v[92:95], v17 offset:9168
    ds_read_b128 v[96:99], v17 offset:256
    ds_read_b128 v[100:103], v17 offset:9232
    ds_read_b128 v[104:107], v17 offset:320
    ds_read_b128 v[108:111], v17 offset:9296
    ds_read_b128 v[112:115], v17 offset:384
    ds_read_b128 v[116:119], v17 offset:9360
    ds_read_b128 v[120:123], v17 offset:448
    ds_read_b128 v[124:127], v17 offset:9424
    s_waitcnt lgkmcnt(14)
    v_mfma_f32_16x16x4_f32 v[60:63], v64, v68, v[60:63]
    v_mfma_f32_16x16x4_f32 v[60:63], v65, v69, v[60:63]
    v_mfma_f32_16x16x4_f32 v[60:63], v66, v70, v[60:63]
    v_mfma_f32_16x16x4_f32 v[60:63], v67, v71, v[60:63]
    s_waitcnt lgkmcnt(12)
    v_mfma_f32_16x16x4_f32 v[60:63], v72, v76, v[60:63]
    v_mfma_f32_16x16x4_f32 v[60:63], v73, v77, v[60:63]
    v_mfma_f32_16x16x4_f32 v[60:63], v74, v78, v[60:63]
    v_mfma_f32_16x16x4_f32 v[60:63], v75, v79, v[60:63]
    s_waitcnt lgkmcnt(10)
    v_mfma_f32_16x16x4_f32 v[60:63], v80, v84, v[60:63]
    v_mfma_f32_16x16x4_f32 v[60:63], v81, v85, v[60:63]
    v_mfma_f32_16x16x4_f32 v[60:63], v82, v86, v[60:63]
    v_mfma_f32_16x16x4_f32 v[60:63], v83, v87, v[60:63]
    s_waitcnt lgkmcnt(8)
    v_mfma_f32_16x16x4_f32 v[60:63], v88, v92, v[60:63]
    v_mfma_f32_16x16x4_f32 v[60:63], v89, v93, v[60:63]
    v_mfma_f32_16x16x4_f32 v[60:63], v90, v94, v[60:63]
    v_mfma_f32_16x16x4_f32 v[60:63], v91, v95, v[60:63]
    s_waitcnt lgkmcnt(6)
    v_mfma_f32_16x16x4_f32 v[60:63], v96, v100, v[60:63]
    v_mfma_f32_16x16x4_f32 v[60:63], v97, v101, v[60:63]
    v_mfma_f32_16x16x4_f32 v[60:63], v98, v102, v[60:63]
    v_mfma_f32_16x16x4_f32 v[60:63], v99, v103, v[60:63]
    s_waitcnt lgkmcnt(4)
    v_mfma_f32_16x16x4_f32 v[60:63], v104, v108, v[60:63]
    v_mfma_f32_16x16x4_f32 v[60:63], v105, v109, v[60:63]
    v_mfma_f32_16x16x4_f32 v[60:63], v106, v110, v[60:63]
    v_mfma_f32_16x16x4_f32 v[60:63], v107, v111, v[60:63]
    s_waitcnt lgkmcnt(2)
    v_mfma_f32_16x16x4_f32 v[60:63], v112, v116, v[60:63]
    v_mfma_f32_16x16x4_f32 v[60:63], v113, v117, v[60:63]
    v_mfma_f32_16x16x4_f32 v[60:63], v114, v118, v[60:63]
    v_mfma_f32_16x16x4_f32 v[60:63], v115, v119, v[60:63]
    s_waitcnt lgkmcnt(0)
    v_mfma_f32_16x16x4_f32 v[60:63], v120, v124, v[60:63]
    v_mfma_f32_16x16x4_f32 v[60:63], v121, v125, v[60:63]
    v_mfma_f32_16x16x4_f32 v[60:63], v122, v126, v[60:63]
    v_mfma_f32_16x16x4_f32 v[60:63], v123, v127, v[60:63]
    s_nop 7
    s_nop 15
    s_lshl_b32 s49, s44, 7
    s_add_u32 s49, s49, 128
    s_cmp_eq_u32 s44, 0
    s_cselect_b32 s49, 0, s49
    s_cselect_b32 s50, 16, 8
    s_cmp_eq_u32 s44, 3
    s_cselect_b32 s50, 9, s50
    s_mul_i32 s51, s3, 2816
    s_lshl_b32 s49, s49, 2
    s_add_u32 s51, s51, s49
    s_add_u32 s51, s51, 8388608
    v_and_b32 v20, 15, v1
    v_lshlrev_b32 v21, 2, v18
    v_lshlrev_b32 v22, 6, v21
    v_lshl_add_u32 v22, v20, 2, v22
    v_add_u32 v23, 0, v21
    v_cmp_gt_u32 vcc, s50, v23
    s_and_saveexec_b64 s[52:53], vcc
    buffer_store_dword v60, v22, s[36:39], s51 offen offset:0
    s_mov_b64 exec, s[52:53]
    v_add_u32 v23, 1, v21
    v_cmp_gt_u32 vcc, s50, v23
    s_and_saveexec_b64 s[52:53], vcc
    buffer_store_dword v61, v22, s[36:39], s51 offen offset:64
    s_mov_b64 exec, s[52:53]
    v_add_u32 v23, 2, v21
    v_cmp_gt_u32 vcc, s50, v23
    s_and_saveexec_b64 s[52:53], vcc
    buffer_store_dword v62, v22, s[36:39], s51 offen offset:128
    s_mov_b64 exec, s[52:53]
    v_add_u32 v23, 3, v21
    v_cmp_gt_u32 vcc, s50, v23
    s_and_saveexec_b64 s[52:53], vcc
    buffer_store_dword v63, v22, s[36:39], s51 offen offset:192
    s_mov_b64 exec, s[52:53]
    s_endpgm
L_prep_kernel_r0:
    s_sub_u32 s3, s2, 448
    s_cmp_ge_u32 s3, 64
    s_cbranch_scc1 L_prep_kernel_r1
    s_load_dwordx2 s[4:5], s[0:1], 0
    s_load_dwordx2 s[6:7], s[0:1], 112
    v_and_b32 v1, 63, v0
    v_lshrrev_b32 v2, 6, v0
    s_nop 0
    v_readfirstlane_b32 s20, v2
    s_waitcnt lgkmcnt(0)
    s_mov_b32 s8, s4
    s_and_b32 s9, s5, 0xffff
    s_mov_b32 s10, 1835008
    s_mov_b32 s11, 0x00020000
    s_mov_b32 s12, s6
    s_and_b32 s13, s7, 0xffff
    s_mov_b32 s14, 268435456
    s_mov_b32 s15, 0x00020000
    s_lshl_b32 s21, s3, 5
    s_lshl_b32 s22, s20, 3
    s_add_u32 s21, s21, s22
    s_mul_i32 s23, s21, 896
    s_mov_b32 s25, s23
    v_lshlrev_b32 v3, 4, v1
    v_mov_b32 v4, 0x7ff00000
    v_cmp_gt_u32 vcc, 56, v1
    s_nop 1
    v_cndmask_b32 v3, v4, v3, vcc
    s_mov_b64 s[26:27], vcc
    buffer_load_dwordx4 v[16:19], v3, s[8:11], s23 offen
    s_add_u32 s23, s23, 896
    buffer_load_dwordx4 v[20:23], v3, s[8:11], s23 offen
    s_add_u32 s23, s23, 896
    buffer_load_dwordx4 v[24:27], v3, s[8:11], s23 offen
    s_add_u32 s23, s23, 896
    buffer_load_dwordx4 v[28:31], v3, s[8:11], s23 offen
    s_add_u32 s23, s23, 896
    buffer_load_dwordx4 v[32:35], v3, s[8:11], s23 offen
    s_add_u32 s23, s23, 896
    buffer_load_dwordx4 v[36:39], v3, s[8:11], s23 offen
    s_add_u32 s23, s23, 896
    buffer_load_dwordx4 v[40:43], v3, s[8:11], s23 offen
    s_add_u32 s23, s23, 896
    buffer_load_dwordx4 v[44:47], v3, s[8:11], s23 offen
    s_add_u32 s23, s23, 896
    v_lshlrev_b32 v5, 4, v1
    s_mul_i32 s28, s20, 7296
    v_add_u32 v5, s28, v5
    s_waitcnt vmcnt(0)
    v_lshlrev_b32 v48, 16, v16
    v_and_b32 v49, 0xffff0000, v16
    v_lshlrev_b32 v50, 16, v17
    v_and_b32 v51, 0xffff0000, v17
    v_lshlrev_b32 v52, 16, v18
    v_and_b32 v53, 0xffff0000, v18
    v_lshlrev_b32 v54, 16, v19
    v_and_b32 v55, 0xffff0000, v19
    v_lshlrev_b32 v56, 16, v20
    v_and_b32 v57, 0xffff0000, v20
    v_lshlrev_b32 v58, 16, v21
    v_and_b32 v59, 0xffff0000, v21
    v_lshlrev_b32 v60, 16, v22
    v_and_b32 v61, 0xffff0000, v22
    v_lshlrev_b32 v62, 16, v23
    v_and_b32 v63, 0xffff0000, v23
    v_lshlrev_b32 v64, 16, v24
    v_and_b32 v65, 0xffff0000, v24
    v_lshlrev_b32 v66, 16, v25
    v_and_b32 v67, 0xffff0000, v25
    v_lshlrev_b32 v68, 16, v26
    v_and_b32 v69, 0xffff0000, v26
    v_lshlrev_b32 v70, 16, v27
    v_and_b32 v71, 0xffff0000, v27
    v_lshlrev_b32 v72, 16, v28
    v_and_b32 v73, 0xffff0000, v28
    v_lshlrev_b32 v74, 16, v29
    v_and_b32 v75, 0xffff0000, v29
    v_lshlrev_b32 v76, 16, v30
    v_and_b32 v77, 0xffff0000, v30
    v_lshlrev_b32 v78, 16, v31
    v_and_b32 v79, 0xffff0000, v31
    v_lshlrev_b32 v80, 16, v32
    v_and_b32 v81, 0xffff0000, v32
    v_lshlrev_b32 v82, 16, v33
    v_and_b32 v83, 0xffff0000, v33
    v_lshlrev_b32 v84, 16, v34
    v_and_b32 v85, 0xffff0000, v34
    v_lshlrev_b32 v86, 16, v35
    v_and_b32 v87, 0xffff0000, v35
    v_lshlrev_b32 v88, 16, v36
    v_and_b32 v89, 0xffff0000, v36
    v_lshlrev_b32 v90, 16, v37
    v_and_b32 v91, 0xffff0000, v37
    v_lshlrev_b32 v92, 16, v38
    v_and_b32 v93, 0xffff0000, v38
    v_lshlrev_b32 v94, 16, v39
    v_and_b32 v95, 0xffff0000, v39
    v_lshlrev_b32 v96, 16, v40
    v_and_b32 v97, 0xffff0000, v40
    v_lshlrev_b32 v98, 16, v41
    v_and_b32 v99, 0xffff0000, v41
    v_lshlrev_b32 v100, 16, v42
    v_and_b32 v101, 0xffff0000, v42
    v_lshlrev_b32 v102, 16, v43
    v_and_b32 v103, 0xffff0000, v43
    v_lshlrev_b32 v104, 16, v44
    v_and_b32 v105, 0xffff0000, v44
    v_lshlrev_b32 v106, 16, v45
    v_and_b32 v107, 0xffff0000, v45
    v_lshlrev_b32 v108, 16, v46
    v_and_b32 v109, 0xffff0000, v46
    v_lshlrev_b32 v110, 16, v47
    v_and_b32 v111, 0xffff0000, v47
    v_add_f32 v112, v48, v49
    v_add_f32 v112, v112, v50
    v_add_f32 v112, v112, v51
    v_add_f32 v112, v112, v52
    v_add_f32 v112, v112, v53
    v_add_f32 v112, v112, v54
    v_add_f32 v112, v112, v55
    v_add_f32 v113, v56, v57
    v_add_f32 v113, v113, v58
    v_add_f32 v113, v113, v59
    v_add_f32 v113, v113, v60
    v_add_f32 v113, v113, v61
    v_add_f32 v113, v113, v62
    v_add_f32 v113, v113, v63
    v_add_f32 v114, v64, v65
    v_add_f32 v114, v114, v66
    v_add_f32 v114, v114, v67
    v_add_f32 v114, v114, v68
    v_add_f32 v114, v114, v69
    v_add_f32 v114, v114, v70
    v_add_f32 v114, v114, v71
    v_add_f32 v115, v72, v73
    v_add_f32 v115, v115, v74
    v_add_f32 v115, v115, v75
    v_add_f32 v115, v115, v76
    v_add_f32 v115, v115, v77
    v_add_f32 v115, v115, v78
    v_add_f32 v115, v115, v79
    v_add_f32 v116, v80, v81
    v_add_f32 v116, v116, v82
    v_add_f32 v116, v116, v83
    v_add_f32 v116, v116, v84
    v_add_f32 v116, v116, v85
    v_add_f32 v116, v116, v86
    v_add_f32 v116, v116, v87
    v_add_f32 v117, v88, v89
    v_add_f32 v117, v117, v90
    v_add_f32 v117, v117, v91
    v_add_f32 v117, v117, v92
    v_add_f32 v117, v117, v93
    v_add_f32 v117, v117, v94
    v_add_f32 v117, v117, v95
    v_add_f32 v118, v96, v97
    v_add_f32 v118, v118, v98
    v_add_f32 v118, v118, v99
    v_add_f32 v118, v118, v100
    v_add_f32 v118, v118, v101
    v_add_f32 v118, v118, v102
    v_add_f32 v118, v118, v103
    v_add_f32 v119, v104, v105
    v_add_f32 v119, v119, v106
    v_add_f32 v119, v119, v107
    v_add_f32 v119, v119, v108
    v_add_f32 v119, v119, v109
    v_add_f32 v119, v119, v110
    v_add_f32 v119, v119, v111
    s_nop 1
    v_add_f32_dpp v112, v112, v112 row_shr:1 row_mask:0xf bank_mask:0xf bound_ctrl:0
    v_add_f32_dpp v113, v113, v113 row_shr:1 row_mask:0xf bank_mask:0xf bound_ctrl:0
    v_add_f32_dpp v114, v114, v114 row_shr:1 row_mask:0xf bank_mask:0xf bound_ctrl:0
    v_add_f32_dpp v115, v115, v115 row_shr:1 row_mask:0xf bank_mask:0xf bound_ctrl:0
    v_add_f32_dpp v116, v116, v116 row_shr:1 row_mask:0xf bank_mask:0xf bound_ctrl:0
    v_add_f32_dpp v117, v117, v117 row_shr:1 row_mask:0xf bank_mask:0xf bound_ctrl:0
    v_add_f32_dpp v118, v118, v118 row_shr:1 row_mask:0xf bank_mask:0xf bound_ctrl:0
    v_add_f32_dpp v119, v119, v119 row_shr:1 row_mask:0xf bank_mask:0xf bound_ctrl:0
    s_nop 1
    v_add_f32_dpp v112, v112, v112 row_shr:2 row_mask:0xf bank_mask:0xf bound_ctrl:0
    v_add_f32_dpp v113, v113, v113 row_shr:2 row_mask:0xf bank_mask:0xf bound_ctrl:0
    v_add_f32_dpp v114, v114, v114 row_shr:2 row_mask:0xf bank_mask:0xf bound_ctrl:0
    v_add_f32_dpp v115, v115, v115 row_shr:2 row_mask:0xf bank_mask:0xf bound_ctrl:0
    v_add_f32_dpp v116, v116, v116 row_shr:2 row_mask:0xf bank_mask:0xf bound_ctrl:0
    v_add_f32_dpp v117, v117, v117 row_shr:2 row_mask:0xf bank_mask:0xf bound_ctrl:0
    v_add_f32_dpp v118, v118, v118 row_shr:2 row_mask:0xf bank_mask:0xf bound_ctrl:0
    v_add_f32_dpp v119, v119, v119 row_shr:2 row_mask:0xf bank_mask:0xf bound_ctrl:0
    s_nop 1
    v_add_f32_dpp v112, v112, v112 row_shr:4 row_mask:0xf bank_mask:0xf bound_ctrl:0
    v_add_f32_dpp v113, v113, v113 row_shr:4 row_mask:0xf bank_mask:0xf bound_ctrl:0
    v_add_f32_dpp v114, v114, v114 row_shr:4 row_mask:0xf bank_mask:0xf bound_ctrl:0
    v_add_f32_dpp v115, v115, v115 row_shr:4 row_mask:0xf bank_mask:0xf bound_ctrl:0
    v_add_f32_dpp v116, v116, v116 row_shr:4 row_mask:0xf bank_mask:0xf bound_ctrl:0
    v_add_f32_dpp v117, v117, v117 row_shr:4 row_mask:0xf bank_mask:0xf bound_ctrl:0
    v_add_f32_dpp v118, v118, v118 row_shr:4 row_mask:0xf bank_mask:0xf bound_ctrl:0
    v_add_f32_dpp v119, v119, v119 row_shr:4 row_mask:0xf bank_mask:0xf bound_ctrl:0
    s_nop 1
    v_add_f32_dpp v112, v112, v112 row_shr:8 row_mask:0xf bank_mask:0xf bound_ctrl:0
    v_add_f32_dpp v113, v113, v113 row_shr:8 row_mask:0xf bank_mask:0xf bound_ctrl:0
    v_add_f32_dpp v114, v114, v114 row_shr:8 row_mask:0xf bank_mask:0xf bound_ctrl:0
    v_add_f32_dpp v115, v115, v115 row_shr:8 row_mask:0xf bank_mask:0xf bound_ctrl:0
    v_add_f32_dpp v116, v116, v116 row_shr:8 row_mask:0xf bank_mask:0xf bound_ctrl:0
    v_add_f32_dpp v117, v117, v117 row_shr:8 row_mask:0xf bank_mask:0xf bound_ctrl:0
    v_add_f32_dpp v118, v118, v118 row_shr:8 row_mask:0xf bank_mask:0xf bound_ctrl:0
    v_add_f32_dpp v119, v119, v119 row_shr:8 row_mask:0xf bank_mask:0xf bound_ctrl:0
    s_nop 1
    v_add_f32_dpp v112, v112, v112 row_bcast:15 row_mask:0xa bank_mask:0xf
    v_add_f32_dpp v113, v113, v113 row_bcast:15 row_mask:0xa bank_mask:0xf
    v_add_f32_dpp v114, v114, v114 row_bcast:15 row_mask:0xa bank_mask:0xf
    v_add_f32_dpp v115, v115, v115 row_bcast:15 row_mask:0xa bank_mask:0xf
    v_add_f32_dpp v116, v116, v116 row_bcast:15 row_mask:0xa bank_mask:0xf
    v_add_f32_dpp v117, v117, v117 row_bcast:15 row_mask:0xa bank_mask:0xf
    v_add_f32_dpp v118, v118, v118 row_bcast:15 row_mask:0xa bank_mask:0xf
    v_add_f32_dpp v119, v119, v119 row_bcast:15 row_mask:0xa bank_mask:0xf
    s_nop 1
    v_add_f32_dpp v112, v112, v112 row_bcast:31 row_mask:0xc bank_mask:0xf
    v_add_f32_dpp v113, v113, v113 row_bcast:31 row_mask:0xc bank_mask:0xf
    v_add_f32_dpp v114, v114, v114 row_bcast:31 row_mask:0xc bank_mask:0xf
    v_add_f32_dpp v115, v115, v115 row_bcast:31 row_mask:0xc bank_mask:0xf
    v_add_f32_dpp v116, v116, v116 row_bcast:31 row_mask:0xc bank_mask:0xf
    v_add_f32_dpp v117, v117, v117 row_bcast:31 row_mask:0xc bank_mask:0xf
    v_add_f32_dpp v118, v118, v118 row_bcast:31 row_mask:0xc bank_mask:0xf
    v_add_f32_dpp v119, v119, v119 row_bcast:31 row_mask:0xc bank_mask:0xf
    s_nop 1
    v_readlane_b32 s30, v112, 63
    v_readlane_b32 s31, v113, 63
    v_readlane_b32 s32, v114, 63
    v_readlane_b32 s33, v115, 63
    v_readlane_b32 s34, v116, 63
    v_readlane_b32 s35, v117, 63
    v_readlane_b32 s36, v118, 63
    v_readlane_b32 s37, v119, 63
    s_nop 1
    v_mov_b32 v6, 0x3b124925
    v_mul_f32 v120, s30, v6
    v_mov_b32 v112, 0
    v_mul_f32 v121, s31, v6
    v_mov_b32 v113, 0
    v_mul_f32 v122, s32, v6
    v_mov_b32 v114, 0
    v_mul_f32 v123, s33, v6
    v_mov_b32 v115, 0
    v_mul_f32 v124, s34, v6
    v_mov_b32 v116, 0
    v_mul_f32 v125, s35, v6
    v_mov_b32 v117, 0
    v_mul_f32 v126, s36, v6
    v_mov_b32 v118, 0
    v_mul_f32 v127, s37, v6
    v_mov_b32 v119, 0
    v_sub_f32 v7, v48, v120
    v_fma_f32 v112, v7, v7, v112
    v_sub_f32 v7, v56, v121
    v_fma_f32 v113, v7, v7, v113
    v_sub_f32 v7, v64, v122
    v_fma_f32 v114, v7, v7, v114
    v_sub_f32 v7, v72, v123
    v_fma_f32 v115, v7, v7, v115
    v_sub_f32 v7, v80, v124
    v_fma_f32 v116, v7, v7, v116
    v_sub_f32 v7, v88, v125
    v_fma_f32 v117, v7, v7, v117
    v_sub_f32 v7, v96, v126
    v_fma_f32 v118, v7, v7, v118
    v_sub_f32 v7, v104, v127
    v_fma_f32 v119, v7, v7, v119
    v_sub_f32 v7, v49, v120
    v_fma_f32 v112, v7, v7, v112
    v_sub_f32 v7, v57, v121
    v_fma_f32 v113, v7, v7, v113
    v_sub_f32 v7, v65, v122
    v_fma_f32 v114, v7, v7, v114
    v_sub_f32 v7, v73, v123
    v_fma_f32 v115, v7, v7, v115
    v_sub_f32 v7, v81, v124
    v_fma_f32 v116, v7, v7, v116
    v_sub_f32 v7, v89, v125
    v_fma_f32 v117, v7, v7, v117
    v_sub_f32 v7, v97, v126
    v_fma_f32 v118, v7, v7, v118
    v_sub_f32 v7, v105, v127
    v_fma_f32 v119, v7, v7, v119
    v_sub_f32 v7, v50, v120
    v_fma_f32 v112, v7, v7, v112
    v_sub_f32 v7, v58, v121
    v_fma_f32 v113, v7, v7, v113
    v_sub_f32 v7, v66, v122
    v_fma_f32 v114, v7, v7, v114
    v_sub_f32 v7, v74, v123
    v_fma_f32 v115, v7, v7, v115
    v_sub_f32 v7, v82, v124
    v_fma_f32 v116, v7, v7, v116
    v_sub_f32 v7, v90, v125
    v_fma_f32 v117, v7, v7, v117
    v_sub_f32 v7, v98, v126
    v_fma_f32 v118, v7, v7, v118
    v_sub_f32 v7, v106, v127
    v_fma_f32 v119, v7, v7, v119
    v_sub_f32 v7, v51, v120
    v_fma_f32 v112, v7, v7, v112
    v_sub_f32 v7, v59, v121
    v_fma_f32 v113, v7, v7, v113
    v_sub_f32 v7, v67, v122
    v_fma_f32 v114, v7, v7, v114
    v_sub_f32 v7, v75, v123
    v_fma_f32 v115, v7, v7, v115
    v_sub_f32 v7, v83, v124
    v_fma_f32 v116, v7, v7, v116
    v_sub_f32 v7, v91, v125
    v_fma_f32 v117, v7, v7, v117
    v_sub_f32 v7, v99, v126
    v_fma_f32 v118, v7, v7, v118
    v_sub_f32 v7, v107, v127
    v_fma_f32 v119, v7, v7, v119
    v_sub_f32 v7, v52, v120
    v_fma_f32 v112, v7, v7, v112
    v_sub_f32 v7, v60, v121
    v_fma_f32 v113, v7, v7, v113
    v_sub_f32 v7, v68, v122
    v_fma_f32 v114, v7, v7, v114
    v_sub_f32 v7, v76, v123
    v_fma_f32 v115, v7, v7, v115
    v_sub_f32 v7, v84, v124
    v_fma_f32 v116, v7, v7, v116
    v_sub_f32 v7, v92, v125
    v_fma_f32 v117, v7, v7, v117
    v_sub_f32 v7, v100, v126
    v_fma_f32 v118, v7, v7, v118
    v_sub_f32 v7, v108, v127
    v_fma_f32 v119, v7, v7, v119
    v_sub_f32 v7, v53, v120
    v_fma_f32 v112, v7, v7, v112
    v_sub_f32 v7, v61, v121
    v_fma_f32 v113, v7, v7, v113
    v_sub_f32 v7, v69, v122
    v_fma_f32 v114, v7, v7, v114
    v_sub_f32 v7, v77, v123
    v_fma_f32 v115, v7, v7, v115
    v_sub_f32 v7, v85, v124
    v_fma_f32 v116, v7, v7, v116
    v_sub_f32 v7, v93, v125
    v_fma_f32 v117, v7, v7, v117
    v_sub_f32 v7, v101, v126
    v_fma_f32 v118, v7, v7, v118
    v_sub_f32 v7, v109, v127
    v_fma_f32 v119, v7, v7, v119
    v_sub_f32 v7, v54, v120
    v_fma_f32 v112, v7, v7, v112
    v_sub_f32 v7, v62, v121
    v_fma_f32 v113, v7, v7, v113
    v_sub_f32 v7, v70, v122
    v_fma_f32 v114, v7, v7, v114
    v_sub_f32 v7, v78, v123
    v_fma_f32 v115, v7, v7, v115
    v_sub_f32 v7, v86, v124
    v_fma_f32 v116, v7, v7, v116
    v_sub_f32 v7, v94, v125
    v_fma_f32 v117, v7, v7, v117
    v_sub_f32 v7, v102, v126
    v_fma_f32 v118, v7, v7, v118
    v_sub_f32 v7, v110, v127
    v_fma_f32 v119, v7, v7, v119
    v_sub_f32 v7, v55, v120
    v_fma_f32 v112, v7, v7, v112
    v_sub_f32 v7, v63, v121
    v_fma_f32 v113, v7, v7, v113
    v_sub_f32 v7, v71, v122
    v_fma_f32 v114, v7, v7, v114
    v_sub_f32 v7, v79, v123
    v_fma_f32 v115, v7, v7, v115
    v_sub_f32 v7, v87, v124
    v_fma_f32 v116, v7, v7, v116
    v_sub_f32 v7, v95, v125
    v_fma_f32 v117, v7, v7, v117
    v_sub_f32 v7, v103, v126
    v_fma_f32 v118, v7, v7, v118
    v_sub_f32 v7, v111, v127
    v_fma_f32 v119, v7, v7, v119
    v_cndmask_b32 v112, 0, v112, s[26:27]
    v_cndmask_b32 v113, 0, v113, s[26:27]
    v_cndmask_b32 v114, 0, v114, s[26:27]
    v_cndmask_b32 v115, 0, v115, s[26:27]
    v_cndmask_b32 v116, 0, v116, s[26:27]
    v_cndmask_b32 v117, 0, v117, s[26:27]
    v_cndmask_b32 v118, 0, v118, s[26:27]
    v_cndmask_b32 v119, 0, v119, s[26:27]
    s_nop 1
    v_add_f32_dpp v112, v112, v112 row_shr:1 row_mask:0xf bank_mask:0xf bound_ctrl:0
    v_add_f32_dpp v113, v113, v113 row_shr:1 row_mask:0xf bank_mask:0xf bound_ctrl:0
    v_add_f32_dpp v114, v114, v114 row_shr:1 row_mask:0xf bank_mask:0xf bound_ctrl:0
    v_add_f32_dpp v115, v115, v115 row_shr:1 row_mask:0xf bank_mask:0xf bound_ctrl:0
    v_add_f32_dpp v116, v116, v116 row_shr:1 row_mask:0xf bank_mask:0xf bound_ctrl:0
    v_add_f32_dpp v117, v117, v117 row_shr:1 row_mask:0xf bank_mask:0xf bound_ctrl:0
    v_add_f32_dpp v118, v118, v118 row_shr:1 row_mask:0xf bank_mask:0xf bound_ctrl:0
    v_add_f32_dpp v119, v119, v119 row_shr:1 row_mask:0xf bank_mask:0xf bound_ctrl:0
    s_nop 1
    v_add_f32_dpp v112, v112, v112 row_shr:2 row_mask:0xf bank_mask:0xf bound_ctrl:0
    v_add_f32_dpp v113, v113, v113 row_shr:2 row_mask:0xf bank_mask:0xf bound_ctrl:0
    v_add_f32_dpp v114, v114, v114 row_shr:2 row_mask:0xf bank_mask:0xf bound_ctrl:0
    v_add_f32_dpp v115, v115, v115 row_shr:2 row_mask:0xf bank_mask:0xf bound_ctrl:0
    v_add_f32_dpp v116, v116, v116 row_shr:2 row_mask:0xf bank_mask:0xf bound_ctrl:0
    v_add_f32_dpp v117, v117, v117 row_shr:2 row_mask:0xf bank_mask:0xf bound_ctrl:0
    v_add_f32_dpp v118, v118, v118 row_shr:2 row_mask:0xf bank_mask:0xf bound_ctrl:0
    v_add_f32_dpp v119, v119, v119 row_shr:2 row_mask:0xf bank_mask:0xf bound_ctrl:0
    s_nop 1
    v_add_f32_dpp v112, v112, v112 row_shr:4 row_mask:0xf bank_mask:0xf bound_ctrl:0
    v_add_f32_dpp v113, v113, v113 row_shr:4 row_mask:0xf bank_mask:0xf bound_ctrl:0
    v_add_f32_dpp v114, v114, v114 row_shr:4 row_mask:0xf bank_mask:0xf bound_ctrl:0
    v_add_f32_dpp v115, v115, v115 row_shr:4 row_mask:0xf bank_mask:0xf bound_ctrl:0
    v_add_f32_dpp v116, v116, v116 row_shr:4 row_mask:0xf bank_mask:0xf bound_ctrl:0
    v_add_f32_dpp v117, v117, v117 row_shr:4 row_mask:0xf bank_mask:0xf bound_ctrl:0
    v_add_f32_dpp v118, v118, v118 row_shr:4 row_mask:0xf bank_mask:0xf bound_ctrl:0
    v_add_f32_dpp v119, v119, v119 row_shr:4 row_mask:0xf bank_mask:0xf bound_ctrl:0
    s_nop 1
    v_add_f32_dpp v112, v112, v112 row_shr:8 row_mask:0xf bank_mask:0xf bound_ctrl:0
    v_add_f32_dpp v113, v113, v113 row_shr:8 row_mask:0xf bank_mask:0xf bound_ctrl:0
    v_add_f32_dpp v114, v114, v114 row_shr:8 row_mask:0xf bank_mask:0xf bound_ctrl:0
    v_add_f32_dpp v115, v115, v115 row_shr:8 row_mask:0xf bank_mask:0xf bound_ctrl:0
    v_add_f32_dpp v116, v116, v116 row_shr:8 row_mask:0xf bank_mask:0xf bound_ctrl:0
    v_add_f32_dpp v117, v117, v117 row_shr:8 row_mask:0xf bank_mask:0xf bound_ctrl:0
    v_add_f32_dpp v118, v118, v118 row_shr:8 row_mask:0xf bank_mask:0xf bound_ctrl:0
    v_add_f32_dpp v119, v119, v119 row_shr:8 row_mask:0xf bank_mask:0xf bound_ctrl:0
    s_nop 1
    v_add_f32_dpp v112, v112, v112 row_bcast:15 row_mask:0xa bank_mask:0xf
    v_add_f32_dpp v113, v113, v113 row_bcast:15 row_mask:0xa bank_mask:0xf
    v_add_f32_dpp v114, v114, v114 row_bcast:15 row_mask:0xa bank_mask:0xf
    v_add_f32_dpp v115, v115, v115 row_bcast:15 row_mask:0xa bank_mask:0xf
    v_add_f32_dpp v116, v116, v116 row_bcast:15 row_mask:0xa bank_mask:0xf
    v_add_f32_dpp v117, v117, v117 row_bcast:15 row_mask:0xa bank_mask:0xf
    v_add_f32_dpp v118, v118, v118 row_bcast:15 row_mask:0xa bank_mask:0xf
    v_add_f32_dpp v119, v119, v119 row_bcast:15 row_mask:0xa bank_mask:0xf
    s_nop 1
    v_add_f32_dpp v112, v112, v112 row_bcast:31 row_mask:0xc bank_mask:0xf
    v_add_f32_dpp v113, v113, v113 row_bcast:31 row_mask:0xc bank_mask:0xf
    v_add_f32_dpp v114, v114, v114 row_bcast:31 row_mask:0xc bank_mask:0xf
    v_add_f32_dpp v115, v115, v115 row_bcast:31 row_mask:0xc bank_mask:0xf
    v_add_f32_dpp v116, v116, v116 row_bcast:31 row_mask:0xc bank_mask:0xf
    v_add_f32_dpp v117, v117, v117 row_bcast:31 row_mask:0xc bank_mask:0xf
    v_add_f32_dpp v118, v118, v118 row_bcast:31 row_mask:0xc bank_mask:0xf
    v_add_f32_dpp v119, v119, v119 row_bcast:31 row_mask:0xc bank_mask:0xf
    s_nop 1
    v_readlane_b32 s30, v112, 63
    v_readlane_b32 s31, v113, 63
    v_readlane_b32 s32, v114, 63
    v_readlane_b32 s33, v115, 63
    v_readlane_b32 s34, v116, 63
    v_readlane_b32 s35, v117, 63
    v_readlane_b32 s36, v118, 63
    v_readlane_b32 s37, v119, 63
    s_nop 1
    v_mul_f32 v112, s30, v6
    v_cvt_pk_bf16_f32 v7, v120, v112
    v_lshlrev_b32 v120, 16, v7
    v_and_b32 v112, 0xffff0000, v7
    v_add_f32 v112, 0x3727c5ac, v112
    v_cvt_pk_bf16_f32 v7, v112, v112
    v_lshlrev_b32 v112, 16, v7
    v_sqrt_f32 v112, v112
    v_mul_f32 v113, s31, v6
    v_cvt_pk_bf16_f32 v7, v121, v113
    v_lshlrev_b32 v121, 16, v7
    v_and_b32 v113, 0xffff0000, v7
    v_add_f32 v113, 0x3727c5ac, v113
    v_cvt_pk_bf16_f32 v7, v113, v113
    v_lshlrev_b32 v113, 16, v7
    v_sqrt_f32 v113, v113
    v_mul_f32 v114, s32, v6
    v_cvt_pk_bf16_f32 v7, v122, v114
    v_lshlrev_b32 v122, 16, v7
    v_and_b32 v114, 0xffff0000, v7
    v_add_f32 v114, 0x3727c5ac, v114
    v_cvt_pk_bf16_f32 v7, v114, v114
    v_lshlrev_b32 v114, 16, v7
    v_sqrt_f32 v114, v114
    v_mul_f32 v115, s33, v6
    v_cvt_pk_bf16_f32 v7, v123, v115
    v_lshlrev_b32 v123, 16, v7
    v_and_b32 v115, 0xffff0000, v7
    v_add_f32 v115, 0x3727c5ac, v115
    v_cvt_pk_bf16_f32 v7, v115, v115
    v_lshlrev_b32 v115, 16, v7
    v_sqrt_f32 v115, v115
    v_mul_f32 v116, s34, v6
    v_cvt_pk_bf16_f32 v7, v124, v116
    v_lshlrev_b32 v124, 16, v7
    v_and_b32 v116, 0xffff0000, v7
    v_add_f32 v116, 0x3727c5ac, v116
    v_cvt_pk_bf16_f32 v7, v116, v116
    v_lshlrev_b32 v116, 16, v7
    v_sqrt_f32 v116, v116
    v_mul_f32 v117, s35, v6
    v_cvt_pk_bf16_f32 v7, v125, v117
    v_lshlrev_b32 v125, 16, v7
    v_and_b32 v117, 0xffff0000, v7
    v_add_f32 v117, 0x3727c5ac, v117
    v_cvt_pk_bf16_f32 v7, v117, v117
    v_lshlrev_b32 v117, 16, v7
    v_sqrt_f32 v117, v117
    v_mul_f32 v118, s36, v6
    v_cvt_pk_bf16_f32 v7, v126, v118
    v_lshlrev_b32 v126, 16, v7
    v_and_b32 v118, 0xffff0000, v7
    v_add_f32 v118, 0x3727c5ac, v118
    v_cvt_pk_bf16_f32 v7, v118, v118
    v_lshlrev_b32 v118, 16, v7
    v_sqrt_f32 v118, v118
    v_mul_f32 v119, s37, v6
    v_cvt_pk_bf16_f32 v7, v127, v119
    v_lshlrev_b32 v127, 16, v7
    v_and_b32 v119, 0xffff0000, v7
    v_add_f32 v119, 0x3727c5ac, v119
    v_cvt_pk_bf16_f32 v7, v119, v119
    v_lshlrev_b32 v119, 16, v7
    v_sqrt_f32 v119, v119
    v_cvt_pk_bf16_f32 v7, v112, v112
    v_lshlrev_b32 v112, 16, v7
    v_rcp_f32 v128, v112
    v_cvt_pk_bf16_f32 v7, v113, v113
    v_lshlrev_b32 v113, 16, v7
    v_rcp_f32 v129, v113
    v_cvt_pk_bf16_f32 v7, v114, v114
    v_lshlrev_b32 v114, 16, v7
    v_rcp_f32 v130, v114
    v_cvt_pk_bf16_f32 v7, v115, v115
    v_lshlrev_b32 v115, 16, v7
    v_rcp_f32 v131, v115
    v_cvt_pk_bf16_f32 v7, v116, v116
    v_lshlrev_b32 v116, 16, v7
    v_rcp_f32 v132, v116
    v_cvt_pk_bf16_f32 v7, v117, v117
    v_lshlrev_b32 v117, 16, v7
    v_rcp_f32 v133, v117
    v_cvt_pk_bf16_f32 v7, v118, v118
    v_lshlrev_b32 v118, 16, v7
    v_rcp_f32 v134, v118
    v_cvt_pk_bf16_f32 v7, v119, v119
    v_lshlrev_b32 v119, 16, v7
    v_rcp_f32 v135, v119
    v_sub_f32 v48, v48, v120
    v_sub_f32 v49, v49, v120
    v_cvt_pk_bf16_f32 v7, v48, v49
    v_lshlrev_b32 v48, 16, v7
    v_and_b32 v49, 0xffff0000, v7
    v_sub_f32 v50, v50, v120
    v_sub_f32 v51, v51, v120
    v_cvt_pk_bf16_f32 v7, v50, v51
    v_lshlrev_b32 v50, 16, v7
    v_and_b32 v51, 0xffff0000, v7
    v_sub_f32 v52, v52, v120
    v_sub_f32 v53, v53, v120
    v_cvt_pk_bf16_f32 v7, v52, v53
    v_lshlrev_b32 v52, 16, v7
    v_and_b32 v53, 0xffff0000, v7
    v_sub_f32 v54, v54, v120
    v_sub_f32 v55, v55, v120
    v_cvt_pk_bf16_f32 v7, v54, v55
    v_lshlrev_b32 v54, 16, v7
    v_and_b32 v55, 0xffff0000, v7
    v_mul_f32 v8, v48, v128
    v_fma_f32 v9, -v8, v112, v48
    v_fma_f32 v48, v9, v128, v8
    v_mul_f32 v8, v49, v128
    v_fma_f32 v9, -v8, v112, v49
    v_fma_f32 v49, v9, v128, v8
    v_mul_f32 v8, v50, v128
    v_fma_f32 v9, -v8, v112, v50
    v_fma_f32 v50, v9, v128, v8
    v_mul_f32 v8, v51, v128
    v_fma_f32 v9, -v8, v112, v51
    v_fma_f32 v51, v9, v128, v8
    v_mul_f32 v8, v52, v128
    v_fma_f32 v9, -v8, v112, v52
    v_fma_f32 v52, v9, v128, v8
    v_mul_f32 v8, v53, v128
    v_fma_f32 v9, -v8, v112, v53
    v_fma_f32 v53, v9, v128, v8
    v_mul_f32 v8, v54, v128
    v_fma_f32 v9, -v8, v112, v54
    v_fma_f32 v54, v9, v128, v8
    v_mul_f32 v8, v55, v128
    v_fma_f32 v9, -v8, v112, v55
    v_fma_f32 v55, v9, v128, v8
    v_cvt_pk_bf16_f32 v16, v48, v49
    v_cvt_pk_bf16_f32 v17, v50, v51
    v_cvt_pk_bf16_f32 v18, v52, v53
    v_cvt_pk_bf16_f32 v19, v54, v55
    buffer_store_dwordx4 v[16:19], v3, s[12:15], s25 offen
    s_add_u32 s25, s25, 896
    v_sub_f32 v56, v56, v121
    v_sub_f32 v57, v57, v121
    v_cvt_pk_bf16_f32 v7, v56, v57
    v_lshlrev_b32 v56, 16, v7
    v_and_b32 v57, 0xffff0000, v7
    v_sub_f32 v58, v58, v121
    v_sub_f32 v59, v59, v121
    v_cvt_pk_bf16_f32 v7, v58, v59
    v_lshlrev_b32 v58, 16, v7
    v_and_b32 v59, 0xffff0000, v7
    v_sub_f32 v60, v60, v121
    v_sub_f32 v61, v61, v121
    v_cvt_pk_bf16_f32 v7, v60, v61
    v_lshlrev_b32 v60, 16, v7
    v_and_b32 v61, 0xffff0000, v7
    v_sub_f32 v62, v62, v121
    v_sub_f32 v63, v63, v121
    v_cvt_pk_bf16_f32 v7, v62, v63
    v_lshlrev_b32 v62, 16, v7
    v_and_b32 v63, 0xffff0000, v7
    v_mul_f32 v8, v56, v129
    v_fma_f32 v9, -v8, v113, v56
    v_fma_f32 v56, v9, v129, v8
    v_mul_f32 v8, v57, v129
    v_fma_f32 v9, -v8, v113, v57
    v_fma_f32 v57, v9, v129, v8
    v_mul_f32 v8, v58, v129
    v_fma_f32 v9, -v8, v113, v58
    v_fma_f32 v58, v9, v129, v8
    v_mul_f32 v8, v59, v129
    v_fma_f32 v9, -v8, v113, v59
    v_fma_f32 v59, v9, v129, v8
    v_mul_f32 v8, v60, v129
    v_fma_f32 v9, -v8, v113, v60
    v_fma_f32 v60, v9, v129, v8
    v_mul_f32 v8, v61, v129
    v_fma_f32 v9, -v8, v113, v61
    v_fma_f32 v61, v9, v129, v8
    v_mul_f32 v8, v62, v129
    v_fma_f32 v9, -v8, v113, v62
    v_fma_f32 v62, v9, v129, v8
    v_mul_f32 v8, v63, v129
    v_fma_f32 v9, -v8, v113, v63
    v_fma_f32 v63, v9, v129, v8
    v_cvt_pk_bf16_f32 v20, v56, v57
    v_cvt_pk_bf16_f32 v21, v58, v59
    v_cvt_pk_bf16_f32 v22, v60, v61
    v_cvt_pk_bf16_f32 v23, v62, v63
    buffer_store_dwordx4 v[20:23], v3, s[12:15], s25 offen
    s_add_u32 s25, s25, 896
    v_sub_f32 v64, v64, v122
    v_sub_f32 v65, v65, v122
    v_cvt_pk_bf16_f32 v7, v64, v65
    v_lshlrev_b32 v64, 16, v7
    v_and_b32 v65, 0xffff0000, v7
    v_sub_f32 v66, v66, v122
    v_sub_f32 v67, v67, v122
    v_cvt_pk_bf16_f32 v7, v66, v67
    v_lshlrev_b32 v66, 16, v7
    v_and_b32 v67, 0xffff0000, v7
    v_sub_f32 v68, v68, v122
    v_sub_f32 v69, v69, v122
    v_cvt_pk_bf16_f32 v7, v68, v69
    v_lshlrev_b32 v68, 16, v7
    v_and_b32 v69, 0xffff0000, v7
    v_sub_f32 v70, v70, v122
    v_sub_f32 v71, v71, v122
    v_cvt_pk_bf16_f32 v7, v70, v71
    v_lshlrev_b32 v70, 16, v7
    v_and_b32 v71, 0xffff0000, v7
    v_mul_f32 v8, v64, v130
    v_fma_f32 v9, -v8, v114, v64
    v_fma_f32 v64, v9, v130, v8
    v_mul_f32 v8, v65, v130
    v_fma_f32 v9, -v8, v114, v65
    v_fma_f32 v65, v9, v130, v8
    v_mul_f32 v8, v66, v130
    v_fma_f32 v9, -v8, v114, v66
    v_fma_f32 v66, v9, v130, v8
    v_mul_f32 v8, v67, v130
    v_fma_f32 v9, -v8, v114, v67
    v_fma_f32 v67, v9, v130, v8
    v_mul_f32 v8, v68, v130
    v_fma_f32 v9, -v8, v114, v68
    v_fma_f32 v68, v9, v130, v8
    v_mul_f32 v8, v69, v130
    v_fma_f32 v9, -v8, v114, v69
    v_fma_f32 v69, v9, v130, v8
    v_mul_f32 v8, v70, v130
    v_fma_f32 v9, -v8, v114, v70
    v_fma_f32 v70, v9, v130, v8
    v_mul_f32 v8, v71, v130
    v_fma_f32 v9, -v8, v114, v71
    v_fma_f32 v71, v9, v130, v8
    v_cvt_pk_bf16_f32 v24, v64, v65
    v_cvt_pk_bf16_f32 v25, v66, v67
    v_cvt_pk_bf16_f32 v26, v68, v69
    v_cvt_pk_bf16_f32 v27, v70, v71
    buffer_store_dwordx4 v[24:27], v3, s[12:15], s25 offen
    s_add_u32 s25, s25, 896
    v_sub_f32 v72, v72, v123
    v_sub_f32 v73, v73, v123
    v_cvt_pk_bf16_f32 v7, v72, v73
    v_lshlrev_b32 v72, 16, v7
    v_and_b32 v73, 0xffff0000, v7
    v_sub_f32 v74, v74, v123
    v_sub_f32 v75, v75, v123
    v_cvt_pk_bf16_f32 v7, v74, v75
    v_lshlrev_b32 v74, 16, v7
    v_and_b32 v75, 0xffff0000, v7
    v_sub_f32 v76, v76, v123
    v_sub_f32 v77, v77, v123
    v_cvt_pk_bf16_f32 v7, v76, v77
    v_lshlrev_b32 v76, 16, v7
    v_and_b32 v77, 0xffff0000, v7
    v_sub_f32 v78, v78, v123
    v_sub_f32 v79, v79, v123
    v_cvt_pk_bf16_f32 v7, v78, v79
    v_lshlrev_b32 v78, 16, v7
    v_and_b32 v79, 0xffff0000, v7
    v_mul_f32 v8, v72, v131
    v_fma_f32 v9, -v8, v115, v72
    v_fma_f32 v72, v9, v131, v8
    v_mul_f32 v8, v73, v131
    v_fma_f32 v9, -v8, v115, v73
    v_fma_f32 v73, v9, v131, v8
    v_mul_f32 v8, v74, v131
    v_fma_f32 v9, -v8, v115, v74
    v_fma_f32 v74, v9, v131, v8
    v_mul_f32 v8, v75, v131
    v_fma_f32 v9, -v8, v115, v75
    v_fma_f32 v75, v9, v131, v8
    v_mul_f32 v8, v76, v131
    v_fma_f32 v9, -v8, v115, v76
    v_fma_f32 v76, v9, v131, v8
    v_mul_f32 v8, v77, v131
    v_fma_f32 v9, -v8, v115, v77
    v_fma_f32 v77, v9, v131, v8
    v_mul_f32 v8, v78, v131
    v_fma_f32 v9, -v8, v115, v78
    v_fma_f32 v78, v9, v131, v8
    v_mul_f32 v8, v79, v131
    v_fma_f32 v9, -v8, v115, v79
    v_fma_f32 v79, v9, v131, v8
    v_cvt_pk_bf16_f32 v28, v72, v73
    v_cvt_pk_bf16_f32 v29, v74, v75
    v_cvt_pk_bf16_f32 v30, v76, v77
    v_cvt_pk_bf16_f32 v31, v78, v79
    buffer_store_dwordx4 v[28:31], v3, s[12:15], s25 offen
    s_add_u32 s25, s25, 896
    v_sub_f32 v80, v80, v124
    v_sub_f32 v81, v81, v124
    v_cvt_pk_bf16_f32 v7, v80, v81
    v_lshlrev_b32 v80, 16, v7
    v_and_b32 v81, 0xffff0000, v7
    v_sub_f32 v82, v82, v124
    v_sub_f32 v83, v83, v124
    v_cvt_pk_bf16_f32 v7, v82, v83
    v_lshlrev_b32 v82, 16, v7
    v_and_b32 v83, 0xffff0000, v7
    v_sub_f32 v84, v84, v124
    v_sub_f32 v85, v85, v124
    v_cvt_pk_bf16_f32 v7, v84, v85
    v_lshlrev_b32 v84, 16, v7
    v_and_b32 v85, 0xffff0000, v7
    v_sub_f32 v86, v86, v124
    v_sub_f32 v87, v87, v124
    v_cvt_pk_bf16_f32 v7, v86, v87
    v_lshlrev_b32 v86, 16, v7
    v_and_b32 v87, 0xffff0000, v7
    v_mul_f32 v8, v80, v132
    v_fma_f32 v9, -v8, v116, v80
    v_fma_f32 v80, v9, v132, v8
    v_mul_f32 v8, v81, v132
    v_fma_f32 v9, -v8, v116, v81
    v_fma_f32 v81, v9, v132, v8
    v_mul_f32 v8, v82, v132
    v_fma_f32 v9, -v8, v116, v82
    v_fma_f32 v82, v9, v132, v8
    v_mul_f32 v8, v83, v132
    v_fma_f32 v9, -v8, v116, v83
    v_fma_f32 v83, v9, v132, v8
    v_mul_f32 v8, v84, v132
    v_fma_f32 v9, -v8, v116, v84
    v_fma_f32 v84, v9, v132, v8
    v_mul_f32 v8, v85, v132
    v_fma_f32 v9, -v8, v116, v85
    v_fma_f32 v85, v9, v132, v8
    v_mul_f32 v8, v86, v132
    v_fma_f32 v9, -v8, v116, v86
    v_fma_f32 v86, v9, v132, v8
    v_mul_f32 v8, v87, v132
    v_fma_f32 v9, -v8, v116, v87
    v_fma_f32 v87, v9, v132, v8
    v_cvt_pk_bf16_f32 v32, v80, v81
    v_cvt_pk_bf16_f32 v33, v82, v83
    v_cvt_pk_bf16_f32 v34, v84, v85
    v_cvt_pk_bf16_f32 v35, v86, v87
    buffer_store_dwordx4 v[32:35], v3, s[12:15], s25 offen
    s_add_u32 s25, s25, 896
    v_sub_f32 v88, v88, v125
    v_sub_f32 v89, v89, v125
    v_cvt_pk_bf16_f32 v7, v88, v89
    v_lshlrev_b32 v88, 16, v7
    v_and_b32 v89, 0xffff0000, v7
    v_sub_f32 v90, v90, v125
    v_sub_f32 v91, v91, v125
    v_cvt_pk_bf16_f32 v7, v90, v91
    v_lshlrev_b32 v90, 16, v7
    v_and_b32 v91, 0xffff0000, v7
    v_sub_f32 v92, v92, v125
    v_sub_f32 v93, v93, v125
    v_cvt_pk_bf16_f32 v7, v92, v93
    v_lshlrev_b32 v92, 16, v7
    v_and_b32 v93, 0xffff0000, v7
    v_sub_f32 v94, v94, v125
    v_sub_f32 v95, v95, v125
    v_cvt_pk_bf16_f32 v7, v94, v95
    v_lshlrev_b32 v94, 16, v7
    v_and_b32 v95, 0xffff0000, v7
    v_mul_f32 v8, v88, v133
    v_fma_f32 v9, -v8, v117, v88
    v_fma_f32 v88, v9, v133, v8
    v_mul_f32 v8, v89, v133
    v_fma_f32 v9, -v8, v117, v89
    v_fma_f32 v89, v9, v133, v8
    v_mul_f32 v8, v90, v133
    v_fma_f32 v9, -v8, v117, v90
    v_fma_f32 v90, v9, v133, v8
    v_mul_f32 v8, v91, v133
    v_fma_f32 v9, -v8, v117, v91
    v_fma_f32 v91, v9, v133, v8
    v_mul_f32 v8, v92, v133
    v_fma_f32 v9, -v8, v117, v92
    v_fma_f32 v92, v9, v133, v8
    v_mul_f32 v8, v93, v133
    v_fma_f32 v9, -v8, v117, v93
    v_fma_f32 v93, v9, v133, v8
    v_mul_f32 v8, v94, v133
    v_fma_f32 v9, -v8, v117, v94
    v_fma_f32 v94, v9, v133, v8
    v_mul_f32 v8, v95, v133
    v_fma_f32 v9, -v8, v117, v95
    v_fma_f32 v95, v9, v133, v8
    v_cvt_pk_bf16_f32 v36, v88, v89
    v_cvt_pk_bf16_f32 v37, v90, v91
    v_cvt_pk_bf16_f32 v38, v92, v93
    v_cvt_pk_bf16_f32 v39, v94, v95
    buffer_store_dwordx4 v[36:39], v3, s[12:15], s25 offen
    s_add_u32 s25, s25, 896
    v_sub_f32 v96, v96, v126
    v_sub_f32 v97, v97, v126
    v_cvt_pk_bf16_f32 v7, v96, v97
    v_lshlrev_b32 v96, 16, v7
    v_and_b32 v97, 0xffff0000, v7
    v_sub_f32 v98, v98, v126
    v_sub_f32 v99, v99, v126
    v_cvt_pk_bf16_f32 v7, v98, v99
    v_lshlrev_b32 v98, 16, v7
    v_and_b32 v99, 0xffff0000, v7
    v_sub_f32 v100, v100, v126
    v_sub_f32 v101, v101, v126
    v_cvt_pk_bf16_f32 v7, v100, v101
    v_lshlrev_b32 v100, 16, v7
    v_and_b32 v101, 0xffff0000, v7
    v_sub_f32 v102, v102, v126
    v_sub_f32 v103, v103, v126
    v_cvt_pk_bf16_f32 v7, v102, v103
    v_lshlrev_b32 v102, 16, v7
    v_and_b32 v103, 0xffff0000, v7
    v_mul_f32 v8, v96, v134
    v_fma_f32 v9, -v8, v118, v96
    v_fma_f32 v96, v9, v134, v8
    v_mul_f32 v8, v97, v134
    v_fma_f32 v9, -v8, v118, v97
    v_fma_f32 v97, v9, v134, v8
    v_mul_f32 v8, v98, v134
    v_fma_f32 v9, -v8, v118, v98
    v_fma_f32 v98, v9, v134, v8
    v_mul_f32 v8, v99, v134
    v_fma_f32 v9, -v8, v118, v99
    v_fma_f32 v99, v9, v134, v8
    v_mul_f32 v8, v100, v134
    v_fma_f32 v9, -v8, v118, v100
    v_fma_f32 v100, v9, v134, v8
    v_mul_f32 v8, v101, v134
    v_fma_f32 v9, -v8, v118, v101
    v_fma_f32 v101, v9, v134, v8
    v_mul_f32 v8, v102, v134
    v_fma_f32 v9, -v8, v118, v102
    v_fma_f32 v102, v9, v134, v8
    v_mul_f32 v8, v103, v134
    v_fma_f32 v9, -v8, v118, v103
    v_fma_f32 v103, v9, v134, v8
    v_cvt_pk_bf16_f32 v40, v96, v97
    v_cvt_pk_bf16_f32 v41, v98, v99
    v_cvt_pk_bf16_f32 v42, v100, v101
    v_cvt_pk_bf16_f32 v43, v102, v103
    buffer_store_dwordx4 v[40:43], v3, s[12:15], s25 offen
    s_add_u32 s25, s25, 896
    v_sub_f32 v104, v104, v127
    v_sub_f32 v105, v105, v127
    v_cvt_pk_bf16_f32 v7, v104, v105
    v_lshlrev_b32 v104, 16, v7
    v_and_b32 v105, 0xffff0000, v7
    v_sub_f32 v106, v106, v127
    v_sub_f32 v107, v107, v127
    v_cvt_pk_bf16_f32 v7, v106, v107
    v_lshlrev_b32 v106, 16, v7
    v_and_b32 v107, 0xffff0000, v7
    v_sub_f32 v108, v108, v127
    v_sub_f32 v109, v109, v127
    v_cvt_pk_bf16_f32 v7, v108, v109
    v_lshlrev_b32 v108, 16, v7
    v_and_b32 v109, 0xffff0000, v7
    v_sub_f32 v110, v110, v127
    v_sub_f32 v111, v111, v127
    v_cvt_pk_bf16_f32 v7, v110, v111
    v_lshlrev_b32 v110, 16, v7
    v_and_b32 v111, 0xffff0000, v7
    v_mul_f32 v8, v104, v135
    v_fma_f32 v9, -v8, v119, v104
    v_fma_f32 v104, v9, v135, v8
    v_mul_f32 v8, v105, v135
    v_fma_f32 v9, -v8, v119, v105
    v_fma_f32 v105, v9, v135, v8
    v_mul_f32 v8, v106, v135
    v_fma_f32 v9, -v8, v119, v106
    v_fma_f32 v106, v9, v135, v8
    v_mul_f32 v8, v107, v135
    v_fma_f32 v9, -v8, v119, v107
    v_fma_f32 v107, v9, v135, v8
    v_mul_f32 v8, v108, v135
    v_fma_f32 v9, -v8, v119, v108
    v_fma_f32 v108, v9, v135, v8
    v_mul_f32 v8, v109, v135
    v_fma_f32 v9, -v8, v119, v109
    v_fma_f32 v109, v9, v135, v8
    v_mul_f32 v8, v110, v135
    v_fma_f32 v9, -v8, v119, v110
    v_fma_f32 v110, v9, v135, v8
    v_mul_f32 v8, v111, v135
    v_fma_f32 v9, -v8, v119, v111
    v_fma_f32 v111, v9, v135, v8
    v_cvt_pk_bf16_f32 v44, v104, v105
    v_cvt_pk_bf16_f32 v45, v106, v107
    v_cvt_pk_bf16_f32 v46, v108, v109
    v_cvt_pk_bf16_f32 v47, v110, v111
    buffer_store_dwordx4 v[44:47], v3, s[12:15], s25 offen
    s_add_u32 s25, s25, 896
    s_mov_b64 exec, s[26:27]
    ds_write_b128 v5, v[16:19] offset:0
    ds_write_b128 v5, v[20:23] offset:912
    ds_write_b128 v5, v[24:27] offset:1824
    ds_write_b128 v5, v[28:31] offset:2736
    ds_write_b128 v5, v[32:35] offset:3648
    ds_write_b128 v5, v[36:39] offset:4560
    ds_write_b128 v5, v[40:43] offset:5472
    ds_write_b128 v5, v[44:47] offset:6384
    s_mov_b64 exec, -1
    s_waitcnt lgkmcnt(0)
    s_barrier
    v_and_b32 v6, 3, v0
    v_lshrrev_b32 v7, 2, v0
    v_mul_u32_u24 v8, 8*912, v6
    v_lshl_add_u32 v8, v7, 1, v8
    v_lshlrev_b32 v9, 12, v7
    v_lshl_add_u32 v9, v6, 4, v9
    s_lshl_b32 s29, s3, 6
    s_add_u32 s29, s29, 2097152
    ds_read_u16 v24, v8 offset:0
    ds_read_u16 v25, v8 offset:912
    ds_read_u16 v26, v8 offset:1824
    ds_read_u16 v27, v8 offset:2736
    ds_read_u16 v28, v8 offset:3648
    ds_read_u16 v29, v8 offset:4560
    ds_read_u16 v30, v8 offset:5472
    ds_read_u16 v31, v8 offset:6384
    s_waitcnt lgkmcnt(0)
    v_lshl_or_b32 v16, v25, 16, v24
    v_lshl_or_b32 v17, v27, 16, v26
    v_lshl_or_b32 v18, v29, 16, v28
    v_lshl_or_b32 v19, v31, 16, v30
    buffer_store_dwordx4 v[16:19], v9, s[12:15], s29 offen
    s_add_u32 s29, s29, 262144
    s_nop 1
    ds_read_u16 v24, v8 offset:128
    ds_read_u16 v25, v8 offset:1040
    ds_read_u16 v26, v8 offset:1952
    ds_read_u16 v27, v8 offset:2864
    ds_read_u16 v28, v8 offset:3776
    ds_read_u16 v29, v8 offset:4688
    ds_read_u16 v30, v8 offset:5600
    ds_read_u16 v31, v8 offset:6512
    s_waitcnt lgkmcnt(0)
    v_lshl_or_b32 v16, v25, 16, v24
    v_lshl_or_b32 v17, v27, 16, v26
    v_lshl_or_b32 v18, v29, 16, v28
    v_lshl_or_b32 v19, v31, 16, v30
    buffer_store_dwordx4 v[16:19], v9, s[12:15], s29 offen
    s_add_u32 s29, s29, 262144
    s_nop 1
    ds_read_u16 v24, v8 offset:256
    ds_read_u16 v25, v8 offset:1168
    ds_read_u16 v26, v8 offset:2080
    ds_read_u16 v27, v8 offset:2992
    ds_read_u16 v28, v8 offset:3904
    ds_read_u16 v29, v8 offset:4816
    ds_read_u16 v30, v8 offset:5728
    ds_read_u16 v31, v8 offset:6640
    s_waitcnt lgkmcnt(0)
    v_lshl_or_b32 v16, v25, 16, v24
    v_lshl_or_b32 v17, v27, 16, v26
    v_lshl_or_b32 v18, v29, 16, v28
    v_lshl_or_b32 v19, v31, 16, v30
    buffer_store_dwordx4 v[16:19], v9, s[12:15], s29 offen
    s_add_u32 s29, s29, 262144
    s_nop 1
    ds_read_u16 v24, v8 offset:384
    ds_read_u16 v25, v8 offset:1296
    ds_read_u16 v26, v8 offset:2208
    ds_read_u16 v27, v8 offset:3120
    ds_read_u16 v28, v8 offset:4032
    ds_read_u16 v29, v8 offset:4944
    ds_read_u16 v30, v8 offset:5856
    ds_read_u16 v31, v8 offset:6768
    s_waitcnt lgkmcnt(0)
    v_lshl_or_b32 v16, v25, 16, v24
    v_lshl_or_b32 v17, v27, 16, v26
    v_lshl_or_b32 v18, v29, 16, v28
    v_lshl_or_b32 v19, v31, 16, v30
    buffer_store_dwordx4 v[16:19], v9, s[12:15], s29 offen
    s_add_u32 s29, s29, 262144
    s_nop 1
    ds_read_u16 v24, v8 offset:512
    ds_read_u16 v25, v8 offset:1424
    ds_read_u16 v26, v8 offset:2336
    ds_read_u16 v27, v8 offset:3248
    ds_read_u16 v28, v8 offset:4160
    ds_read_u16 v29, v8 offset:5072
    ds_read_u16 v30, v8 offset:5984
    ds_read_u16 v31, v8 offset:6896
    s_waitcnt lgkmcnt(0)
    v_lshl_or_b32 v16, v25, 16, v24
    v_lshl_or_b32 v17, v27, 16, v26
    v_lshl_or_b32 v18, v29, 16, v28
    v_lshl_or_b32 v19, v31, 16, v30
    buffer_store_dwordx4 v[16:19], v9, s[12:15], s29 offen
    s_add_u32 s29, s29, 262144
    s_nop 1
    ds_read_u16 v24, v8 offset:640
    ds_read_u16 v25, v8 offset:1552
    ds_read_u16 v26, v8 offset:2464
    ds_read_u16 v27, v8 offset:3376
    ds_read_u16 v28, v8 offset:4288
    ds_read_u16 v29, v8 offset:5200
    ds_read_u16 v30, v8 offset:6112
    ds_read_u16 v31, v8 offset:7024
    s_waitcnt lgkmcnt(0)
    v_lshl_or_b32 v16, v25, 16, v24
    v_lshl_or_b32 v17, v27, 16, v26
    v_lshl_or_b32 v18, v29, 16, v28
    v_lshl_or_b32 v19, v31, 16, v30
    buffer_store_dwordx4 v[16:19], v9, s[12:15], s29 offen
    s_add_u32 s29, s29, 262144
    s_nop 1
    ds_read_u16 v24, v8 offset:768
    ds_read_u16 v25, v8 offset:1680
    ds_read_u16 v26, v8 offset:2592
    ds_read_u16 v27, v8 offset:3504
    ds_read_u16 v28, v8 offset:4416
    ds_read_u16 v29, v8 offset:5328
    ds_read_u16 v30, v8 offset:6240
    ds_read_u16 v31, v8 offset:7152
    s_waitcnt lgkmcnt(0)
    v_lshl_or_b32 v16, v25, 16, v24
    v_lshl_or_b32 v17, v27, 16, v26
    v_lshl_or_b32 v18, v29, 16, v28
    v_lshl_or_b32 v19, v31, 16, v30
    buffer_store_dwordx4 v[16:19], v9, s[12:15], s29 offen
    s_add_u32 s29, s29, 262144
    s_nop 1
    s_endpgm
L_prep_kernel_r1:
    s_sub_u32 s3, s2, 512
    s_cmp_ge_u32 s3, 392
    s_cbranch_scc1 L_prep_kernel_r2
    s_load_dwordx2 s[4:5], s[0:1], 64
    s_load_dwordx2 s[16:17], s[0:1], 80
    s_load_dwordx2 s[6:7], s[0:1], 112
    s_waitcnt lgkmcnt(0)
    s_mov_b32 s12, s6
    s_and_b32 s13, s7, 0xffff
    s_mov_b32 s14, 268435456
    s_mov_b32 s15, 0x00020000
    s_cmp_ge_u32 s3, 196
    s_cbranch_scc1 L_tr_w2
    s_mul_hi_u32 s20, s3, 153391690
    s_mul_i32 s21, s20, 28
    s_sub_u32 s21, s3, s21
    s_mov_b32 s22, 3584
    s_mov_b32 s23, 896
    s_mov_b32 s24, 4194304
    s_branch L_tr_go
L_tr_w2:
    s_sub_u32 s25, s3, 196
    s_mul_hi_u32 s20, s25, 613566757
    s_mul_i32 s21, s20, 7
    s_sub_u32 s21, s25, s21
    s_mov_b32 s4, s16
    s_mov_b32 s5, s17
    s_mov_b32 s22, 896
    s_mov_b32 s23, 3584
    s_mov_b32 s24, 6291456
L_tr_go:
    s_mov_b32 s8, s4
    s_and_b32 s9, s5, 0xffff
    s_mov_b32 s10, 1605632
    s_mov_b32 s11, 0x00020000
    s_lshl_b32 s26, s20, 6
    s_mul_i32 s26, s26, s22
    s_lshl_b32 s27, s21, 7
    s_add_u32 s26, s26, s27
    s_lshl_b32 s27, s21, 6
    s_mul_i32 s27, s27, s23
    s_lshl_b32 s28, s20, 7
    s_add_u32 s27, s27, s28
    s_add_u32 s27, s27, s24
    v_and_b32 v1, 7, v0
    v_lshrrev_b32 v2, 3, v0
    v_mul_lo_u32 v3, v2, s22
    v_lshl_add_u32 v3, v1, 4, v3
    s_lshl_b32 s29, s22, 5
    s_add_u32 s29, s29, s26
    buffer_load_dwordx4 v[8:11], v3, s[8:11], s26 offen
    buffer_load_dwordx4 v[12:15], v3, s[8:11], s29 offen
    v_mul_u32_u24 v4, 144, v2
    v_lshl_add_u32 v4, v1, 4, v4
    s_waitcnt vmcnt(1)
    ds_write_b128 v4, v[8:11]
    s_waitcnt vmcnt(0)
    ds_write_b128 v4, v[12:15] offset:4608
    s_waitcnt lgkmcnt(0)
    s_barrier
    v_mul_u32_u24 v5, 8*144, v1
    v_lshl_add_u32 v5, v2, 1, v5
    v_mul_lo_u32 v6, v2, s23
    v_lshl_add_u32 v6, v1, 4, v6
    s_lshl_b32 s29, s23, 5
    s_add_u32 s29, s29, s27
    ds_read_u16 v16, v5 offset:0
    ds_read_u16 v17, v5 offset:144
    ds_read_u16 v18, v5 offset:288
    ds_read_u16 v19, v5 offset:432
    ds_read_u16 v20, v5 offset:576
    ds_read_u16 v21, v5 offset:720
    ds_read_u16 v22, v5 offset:864
    ds_read_u16 v23, v5 offset:1008
    ds_read_u16 v24, v5 offset:64
    ds_read_u16 v25, v5 offset:208
    ds_read_u16 v26, v5 offset:352
    ds_read_u16 v27, v5 offset:496
    ds_read_u16 v28, v5 offset:640
    ds_read_u16 v29, v5 offset:784
    ds_read_u16 v30, v5 offset:928
    ds_read_u16 v31, v5 offset:1072
    s_waitcnt lgkmcnt(0)
    v_lshl_or_b32 v8, v17, 16, v16
    v_lshl_or_b32 v9, v19, 16, v18
    v_lshl_or_b32 v10, v21, 16, v20
    v_lshl_or_b32 v11, v23, 16, v22
    v_lshl_or_b32 v12, v25, 16, v24
    v_lshl_or_b32 v13, v27, 16, v26
    v_lshl_or_b32 v14, v29, 16, v28
    v_lshl_or_b32 v15, v31, 16, v30
    buffer_store_dwordx4 v[8:11], v6, s[12:15], s27 offen
    buffer_store_dwordx4 v[12:15], v6, s[12:15], s29 offen
    s_endpgm
L_prep_kernel_r2:
    s_endpgm
.text
.globl mid_kernel
.p2align 8
.type mid_kernel,@function
mid_kernel:
    s_sub_u32 s3, s2, 0
    s_cmp_ge_u32 s3, 224
    s_cbranch_scc1 L_mid_kernel_r0
    s_load_dwordx2 s[4:5], s[0:1], 72
    s_load_dwordx2 s[6:7], s[0:1], 112
    s_mul_hi_u32 s20, s3, 306783379
    s_mul_i32 s21, s20, 14
    s_sub_u32 s21, s3, s21
    v_and_b32 v1, 63, v0
    v_lshrrev_b32 v2, 6, v0
    s_nop 0
    v_readfirstlane_b32 s22, v2
    s_waitcnt lgkmcnt(0)
    s_mov_b32 s8, s4
    s_and_b32 s9, s5, 0xffff
    s_mov_b32 s10, 3584
    s_mov_b32 s11, 0x00020000
    s_mov_b32 s12, s6
    s_and_b32 s13, s7, 0xffff
    s_mov_b32 s14, 268435456
    s_mov_b32 s15, 0x00020000
    s_lshr_b32 s23, s22, 1
    s_and_b32 s24, s22, 1
    v_lshrrev_b32 v3, 3, v0
    v_and_b32 v4, 7, v0
    v_mul_u32_u24 v5, 896, v3
    v_lshl_add_u32 v5, v4, 4, v5
    s_mul_i32 s25, s20, 128*896
    s_mul_i32 s26, s21, 128*896
    s_add_u32 s26, s26, 4194304
    v_add_u32 v6, 0, v5
    v_add_u32 v7, 28672, v5
    v_add_u32 v8, 57344, v5
    v_add_u32 v9, 86016, v5
    v_mul_u32_u24 v10, 144, v3
    v_lshl_add_u32 v10, v4, 4, v10
    v_add_u32 v80, 36864, v10
    v_and_b32 v11, 31, v1
    v_lshrrev_b32 v12, 5, v1
    v_mul_u32_u24 v13, 144, v11
    v_lshl_add_u32 v13, v12, 4, v13
    s_mul_i32 s27, s23, 64*144
    s_mul_i32 s28, s24, 64*144
    s_add_u32 s28, s28, 18432
    v_add_u32 v14, s27, v13
    v_add_u32 v15, s28, v13
    s_add_u32 s29, s25, 0
    s_add_u32 s30, s26, 0
    buffer_load_dwordx4 v[16:19], v6, s[12:15], s29 offen
    buffer_load_dwordx4 v[20:23], v7, s[12:15], s29 offen
    buffer_load_dwordx4 v[24:27], v8, s[12:15], s29 offen
    buffer_load_dwordx4 v[28:31], v9, s[12:15], s29 offen
    buffer_load_dwordx4 v[32:35], v6, s[12:15], s30 offen
    buffer_load_dwordx4 v[36:39], v7, s[12:15], s30 offen
    buffer_load_dwordx4 v[40:43], v8, s[12:15], s30 offen
    buffer_load_dwordx4 v[44:47], v9, s[12:15], s30 offen
    s_add_u32 s29, s25, 128
    s_add_u32 s30, s26, 128
    buffer_load_dwordx4 v[160:163], v6, s[12:15], s29 offen
    buffer_load_dwordx4 v[164:167], v7, s[12:15], s29 offen
    buffer_load_dwordx4 v[168:171], v8, s[12:15], s29 offen
    buffer_load_dwordx4 v[172:175], v9, s[12:15], s29 offen
    buffer_load_dwordx4 v[176:179], v6, s[12:15], s30 offen
    buffer_load_dwordx4 v[180:183], v7, s[12:15], s30 offen
    buffer_load_dwordx4 v[184:187], v8, s[12:15], s30 offen
    buffer_load_dwordx4 v[188:191], v9, s[12:15], s30 offen
    v_mov_b32 v96, 0
    v_mov_b32 v97, 0
    v_mov_b32 v98, 0
    v_mov_b32 v99, 0
    v_mov_b32 v100, 0
    v_mov_b32 v101, 0
    v_mov_b32 v102, 0
    v_mov_b32 v103, 0
    v_mov_b32 v104, 0
    v_mov_b32 v105, 0
    v_mov_b32 v106, 0
    v_mov_b32 v107, 0
    v_mov_b32 v108, 0
    v_mov_b32 v109, 0
    v_mov_b32 v110, 0
    v_mov_b32 v111, 0
    v_mov_b32 v112, 0
    v_mov_b32 v113, 0
    v_mov_b32 v114, 0
    v_mov_b32 v115, 0
    v_mov_b32 v116, 0
    v_mov_b32 v117, 0
    v_mov_b32 v118, 0
    v_mov_b32 v119, 0
    v_mov_b32 v120, 0
    v_mov_b32 v121, 0
    v_mov_b32 v122, 0
    v_mov_b32 v123, 0
    v_mov_b32 v124, 0
    v_mov_b32 v125, 0
    v_mov_b32 v126, 0
    v_mov_b32 v127, 0
    v_mov_b32 v128, 0
    v_mov_b32 v129, 0
    v_mov_b32 v130, 0
    v_mov_b32 v131, 0
    v_mov_b32 v132, 0
    v_mov_b32 v133, 0
    v_mov_b32 v134, 0
    v_mov_b32 v135, 0
    v_mov_b32 v136, 0
    v_mov_b32 v137, 0
    v_mov_b32 v138, 0
    v_mov_b32 v139, 0
    v_mov_b32 v140, 0
    v_mov_b32 v141, 0
    v_mov_b32 v142, 0
    v_mov_b32 v143, 0
    v_mov_b32 v144, 0
    v_mov_b32 v145, 0
    v_mov_b32 v146, 0
    v_mov_b32 v147, 0
    v_mov_b32 v148, 0
    v_mov_b32 v149, 0
    v_mov_b32 v150, 0
    v_mov_b32 v151, 0
    v_mov_b32 v152, 0
    v_mov_b32 v153, 0
    v_mov_b32 v154, 0
    v_mov_b32 v155, 0
    v_mov_b32 v156, 0
    v_mov_b32 v157, 0
    v_mov_b32 v158, 0
    v_mov_b32 v159, 0
    s_waitcnt vmcnt(8)
    ds_write_b128 v10, v[16:19] offset:0
    ds_write_b128 v10, v[20:23] offset:4608
    ds_write_b128 v10, v[24:27] offset:9216
    ds_write_b128 v10, v[28:31] offset:13824
    ds_write_b128 v10, v[32:35] offset:18432
    ds_write_b128 v10, v[36:39] offset:23040
    ds_write_b128 v10, v[40:43] offset:27648
    ds_write_b128 v10, v[44:47] offset:32256
    s_waitcnt lgkmcnt(0)
    s_barrier
    s_add_u32 s29, s25, 256
    s_add_u32 s30, s26, 256
    buffer_load_dwordx4 v[16:19], v6, s[12:15], s29 offen
    buffer_load_dwordx4 v[20:23], v7, s[12:15], s29 offen
    buffer_load_dwordx4 v[24:27], v8, s[12:15], s29 offen
    buffer_load_dwordx4 v[28:31], v9, s[12:15], s29 offen
    buffer_load_dwordx4 v[32:35], v6, s[12:15], s30 offen
    buffer_load_dwordx4 v[36:39], v7, s[12:15], s30 offen
    buffer_load_dwordx4 v[40:43], v8, s[12:15], s30 offen
    buffer_load_dwordx4 v[44:47], v9, s[12:15], s30 offen
    ds_read_b128 v[192:195], v14 offset:0
    ds_read_b128 v[196:199], v14 offset:4608
    ds_read_b128 v[200:203], v15 offset:0
    ds_read_b128 v[204:207], v15 offset:4608
    ds_read_b128 v[208:211], v14 offset:32
    ds_read_b128 v[212:215], v14 offset:4640
    ds_read_b128 v[216:219], v15 offset:32
    ds_read_b128 v[220:223], v15 offset:4640
    ds_read_b128 v[224:227], v14 offset:64
    ds_read_b128 v[228:231], v14 offset:4672
    ds_read_b128 v[232:235], v15 offset:64
    ds_read_b128 v[236:239], v15 offset:4672
    ds_read_b128 v[240:243], v14 offset:96
    ds_read_b128 v[244:247], v14 offset:4704
    ds_read_b128 v[248:251], v15 offset:96
    ds_read_b128 v[252:255], v15 offset:4704
    s_waitcnt lgkmcnt(12)
    v_mfma_f32_32x32x16_bf16 v[96:111], v[192:195], v[200:203], v[96:111]
    v_mfma_f32_32x32x16_bf16 v[112:127], v[192:195], v[204:207], v[112:127]
    v_mfma_f32_32x32x16_bf16 v[128:143], v[196:199], v[200:203], v[128:143]
    v_mfma_f32_32x32x16_bf16 v[144:159], v[196:199], v[204:207], v[144:159]
    s_waitcnt lgkmcnt(8)
    v_mfma_f32_32x32x16_bf16 v[96:111], v[208:211], v[216:219], v[96:111]
    v_mfma_f32_32x32x16_bf16 v[112:127], v[208:211], v[220:223], v[112:127]
    v_mfma_f32_32x32x16_bf16 v[128:143], v[212:215], v[216:219], v[128:143]
    v_mfma_f32_32x32x16_bf16 v[144:159], v[212:215], v[220:223], v[144:159]
    s_waitcnt lgkmcnt(4)
    v_mfma_f32_32x32x16_bf16 v[96:111], v[224:227], v[232:235], v[96:111]
    v_mfma_f32_32x32x16_bf16 v[112:127], v[224:227], v[236:239], v[112:127]
    v_mfma_f32_32x32x16_bf16 v[128:143], v[228:231], v[232:235], v[128:143]
    v_mfma_f32_32x32x16_bf16 v[144:159], v[228:231], v[236:239], v[144:159]
    s_waitcnt lgkmcnt(0)
    v_mfma_f32_32x32x16_bf16 v[96:111], v[240:243], v[248:251], v[96:111]
    v_mfma_f32_32x32x16_bf16 v[112:127], v[240:243], v[252:255], v[112:127]
    v_mfma_f32_32x32x16_bf16 v[128:143], v[244:247], v[248:251], v[128:143]
    v_mfma_f32_32x32x16_bf16 v[144:159], v[244:247], v[252:255], v[144:159]
    s_waitcnt vmcnt(8)
    ds_write_b128 v80, v[160:163] offset:0
    ds_write_b128 v80, v[164:167] offset:4608
    ds_write_b128 v80, v[168:171] offset:9216
    ds_write_b128 v80, v[172:175] offset:13824
    ds_write_b128 v80, v[176:179] offset:18432
    ds_write_b128 v80, v[180:183] offset:23040
    ds_write_b128 v80, v[184:187] offset:27648
    ds_write_b128 v80, v[188:191] offset:32256
    s_waitcnt lgkmcnt(0)
    s_barrier
    s_add_u32 s29, s25, 384
    s_add_u32 s30, s26, 384
    buffer_load_dwordx4 v[160:163], v6, s[12:15], s29 offen
    buffer_load_dwordx4 v[164:167], v7, s[12:15], s29 offen
    buffer_load_dwordx4 v[168:171], v8, s[12:15], s29 offen
    buffer_load_dwordx4 v[172:175], v9, s[12:15], s29 offen
    buffer_load_dwordx4 v[176:179], v6, s[12:15], s30 offen
    buffer_load_dwordx4 v[180:183], v7, s[12:15], s30 offen
    buffer_load_dwordx4 v[184:187], v8, s[12:15], s30 offen
    buffer_load_dwordx4 v[188:191], v9, s[12:15], s30 offen
    ds_read_b128 v[192:195], v14 offset:36864
    ds_read_b128 v[196:199], v14 offset:41472
    ds_read_b128 v[200:203], v15 offset:36864
    ds_read_b128 v[204:207], v15 offset:41472
    ds_read_b128 v[208:211], v14 offset:36896
    ds_read_b128 v[212:215], v14 offset:41504
    ds_read_b128 v[216:219], v15 offset:36896
    ds_read_b128 v[220:223], v15 offset:41504
    ds_read_b128 v[224:227], v14 offset:36928
    ds_read_b128 v[228:231], v14 offset:41536
    ds_read_b128 v[232:235], v15 offset:36928
    ds_read_b128 v[236:239], v15 offset:41536
    ds_read_b128 v[240:243], v14 offset:36960
    ds_read_b128 v[244:247], v14 offset:41568
    ds_read_b128 v[248:251], v15 offset:36960
    ds_read_b128 v[252:255], v15 offset:41568
    s_waitcnt lgkmcnt(12)
    v_mfma_f32_32x32x16_bf16 v[96:111], v[192:195], v[200:203], v[96:111]
    v_mfma_f32_32x32x16_bf16 v[112:127], v[192:195], v[204:207], v[112:127]
    v_mfma_f32_32x32x16_bf16 v[128:143], v[196:199], v[200:203], v[128:143]
    v_mfma_f32_32x32x16_bf16 v[144:159], v[196:199], v[204:207], v[144:159]
    s_waitcnt lgkmcnt(8)
    v_mfma_f32_32x32x16_bf16 v[96:111], v[208:211], v[216:219], v[96:111]
    v_mfma_f32_32x32x16_bf16 v[112:127], v[208:211], v[220:223], v[112:127]
    v_mfma_f32_32x32x16_bf16 v[128:143], v[212:215], v[216:219], v[128:143]
    v_mfma_f32_32x32x16_bf16 v[144:159], v[212:215], v[220:223], v[144:159]
    s_waitcnt lgkmcnt(4)
    v_mfma_f32_32x32x16_bf16 v[96:111], v[224:227], v[232:235], v[96:111]
    v_mfma_f32_32x32x16_bf16 v[112:127], v[224:227], v[236:239], v[112:127]
    v_mfma_f32_32x32x16_bf16 v[128:143], v[228:231], v[232:235], v[128:143]
    v_mfma_f32_32x32x16_bf16 v[144:159], v[228:231], v[236:239], v[144:159]
    s_waitcnt lgkmcnt(0)
    v_mfma_f32_32x32x16_bf16 v[96:111], v[240:243], v[248:251], v[96:111]
    v_mfma_f32_32x32x16_bf16 v[112:127], v[240:243], v[252:255], v[112:127]
    v_mfma_f32_32x32x16_bf16 v[128:143], v[244:247], v[248:251], v[128:143]
    v_mfma_f32_32x32x16_bf16 v[144:159], v[244:247], v[252:255], v[144:159]
    s_waitcnt vmcnt(8)
    ds_write_b128 v10, v[16:19] offset:0
    ds_write_b128 v10, v[20:23] offset:4608
    ds_write_b128 v10, v[24:27] offset:9216
    ds_write_b128 v10, v[28:31] offset:13824
    ds_write_b128 v10, v[32:35] offset:18432
    ds_write_b128 v10, v[36:39] offset:23040
    ds_write_b128 v10, v[40:43] offset:27648
    ds_write_b128 v10, v[44:47] offset:32256
    s_waitcnt lgkmcnt(0)
    s_barrier
    s_add_u32 s29, s25, 512
    s_add_u32 s30, s26, 512
    buffer_load_dwordx4 v[16:19], v6, s[12:15], s29 offen
    buffer_load_dwordx4 v[20:23], v7, s[12:15], s29 offen
    buffer_load_dwordx4 v[24:27], v8, s[12:15], s29 offen
    buffer_load_dwordx4 v[28:31], v9, s[12:15], s29 offen
    buffer_load_dwordx4 v[32:35], v6, s[12:15], s30 offen
    buffer_load_dwordx4 v[36:39], v7, s[12:15], s30 offen
    buffer_load_dwordx4 v[40:43], v8, s[12:15], s30 offen
    buffer_load_dwordx4 v[44:47], v9, s[12:15], s30 offen
    ds_read_b128 v[192:195], v14 offset:0
    ds_read_b128 v[196:199], v14 offset:4608
    ds_read_b128 v[200:203], v15 offset:0
    ds_read_b128 v[204:207], v15 offset:4608
    ds_read_b128 v[208:211], v14 offset:32
    ds_read_b128 v[212:215], v14 offset:4640
    ds_read_b128 v[216:219], v15 offset:32
    ds_read_b128 v[220:223], v15 offset:4640
    ds_read_b128 v[224:227], v14 offset:64
    ds_read_b128 v[228:231], v14 offset:4672
    ds_read_b128 v[232:235], v15 offset:64
    ds_read_b128 v[236:239], v15 offset:4672
    ds_read_b128 v[240:243], v14 offset:96
    ds_read_b128 v[244:247], v14 offset:4704
    ds_read_b128 v[248:251], v15 offset:96
    ds_read_b128 v[252:255], v15 offset:4704
    s_waitcnt lgkmcnt(12)
    v_mfma_f32_32x32x16_bf16 v[96:111], v[192:195], v[200:203], v[96:111]
    v_mfma_f32_32x32x16_bf16 v[112:127], v[192:195], v[204:207], v[112:127]
    v_mfma_f32_32x32x16_bf16 v[128:143], v[196:199], v[200:203], v[128:143]
    v_mfma_f32_32x32x16_bf16 v[144:159], v[196:199], v[204:207], v[144:159]
    s_waitcnt lgkmcnt(8)
    v_mfma_f32_32x32x16_bf16 v[96:111], v[208:211], v[216:219], v[96:111]
    v_mfma_f32_32x32x16_bf16 v[112:127], v[208:211], v[220:223], v[112:127]
    v_mfma_f32_32x32x16_bf16 v[128:143], v[212:215], v[216:219], v[128:143]
    v_mfma_f32_32x32x16_bf16 v[144:159], v[212:215], v[220:223], v[144:159]
    s_waitcnt lgkmcnt(4)
    v_mfma_f32_32x32x16_bf16 v[96:111], v[224:227], v[232:235], v[96:111]
    v_mfma_f32_32x32x16_bf16 v[112:127], v[224:227], v[236:239], v[112:127]
    v_mfma_f32_32x32x16_bf16 v[128:143], v[228:231], v[232:235], v[128:143]
    v_mfma_f32_32x32x16_bf16 v[144:159], v[228:231], v[236:239], v[144:159]
    s_waitcnt lgkmcnt(0)
    v_mfma_f32_32x32x16_bf16 v[96:111], v[240:243], v[248:251], v[96:111]
    v_mfma_f32_32x32x16_bf16 v[112:127], v[240:243], v[252:255], v[112:127]
    v_mfma_f32_32x32x16_bf16 v[128:143], v[244:247], v[248:251], v[128:143]
    v_mfma_f32_32x32x16_bf16 v[144:159], v[244:247], v[252:255], v[144:159]
    s_waitcnt vmcnt(8)
    ds_write_b128 v80, v[160:163] offset:0
    ds_write_b128 v80, v[164:167] offset:4608
    ds_write_b128 v80, v[168:171] offset:9216
    ds_write_b128 v80, v[172:175] offset:13824
    ds_write_b128 v80, v[176:179] offset:18432
    ds_write_b128 v80, v[180:183] offset:23040
    ds_write_b128 v80, v[184:187] offset:27648
    ds_write_b128 v80, v[188:191] offset:32256
    s_waitcnt lgkmcnt(0)
    s_barrier
    s_add_u32 s29, s25, 640
    s_add_u32 s30, s26, 640
    buffer_load_dwordx4 v[160:163], v6, s[12:15], s29 offen
    buffer_load_dwordx4 v[164:167], v7, s[12:15], s29 offen
    buffer_load_dwordx4 v[168:171], v8, s[12:15], s29 offen
    buffer_load_dwordx4 v[172:175], v9, s[12:15], s29 offen
    buffer_load_dwordx4 v[176:179], v6, s[12:15], s30 offen
    buffer_load_dwordx4 v[180:183], v7, s[12:15], s30 offen
    buffer_load_dwordx4 v[184:187], v8, s[12:15], s30 offen
    buffer_load_dwordx4 v[188:191], v9, s[12:15], s30 offen
    ds_read_b128 v[192:195], v14 offset:36864
    ds_read_b128 v[196:199], v14 offset:41472
    ds_read_b128 v[200:203], v15 offset:36864
    ds_read_b128 v[204:207], v15 offset:41472
    ds_read_b128 v[208:211], v14 offset:36896
    ds_read_b128 v[212:215], v14 offset:41504
    ds_read_b128 v[216:219], v15 offset:36896
    ds_read_b128 v[220:223], v15 offset:41504
    ds_read_b128 v[224:227], v14 offset:36928
    ds_read_b128 v[228:231], v14 offset:41536
    ds_read_b128 v[232:235], v15 offset:36928
    ds_read_b128 v[236:239], v15 offset:41536
    ds_read_b128 v[240:243], v14 offset:36960
    ds_read_b128 v[244:247], v14 offset:41568
    ds_read_b128 v[248:251], v15 offset:36960
    ds_read_b128 v[252:255], v15 offset:41568
    s_waitcnt lgkmcnt(12)
    v_mfma_f32_32x32x16_bf16 v[96:111], v[192:195], v[200:203], v[96:111]
    v_mfma_f32_32x32x16_bf16 v[112:127], v[192:195], v[204:207], v[112:127]
    v_mfma_f32_32x32x16_bf16 v[128:143], v[196:199], v[200:203], v[128:143]
    v_mfma_f32_32x32x16_bf16 v[144:159], v[196:199], v[204:207], v[144:159]
    s_waitcnt lgkmcnt(8)
    v_mfma_f32_32x32x16_bf16 v[96:111], v[208:211], v[216:219], v[96:111]
    v_mfma_f32_32x32x16_bf16 v[112:127], v[208:211], v[220:223], v[112:127]
    v_mfma_f32_32x32x16_bf16 v[128:143], v[212:215], v[216:219], v[128:143]
    v_mfma_f32_32x32x16_bf16 v[144:159], v[212:215], v[220:223], v[144:159]
    s_waitcnt lgkmcnt(4)
    v_mfma_f32_32x32x16_bf16 v[96:111], v[224:227], v[232:235], v[96:111]
    v_mfma_f32_32x32x16_bf16 v[112:127], v[224:227], v[236:239], v[112:127]
    v_mfma_f32_32x32x16_bf16 v[128:143], v[228:231], v[232:235], v[128:143]
    v_mfma_f32_32x32x16_bf16 v[144:159], v[228:231], v[236:239], v[144:159]
    s_waitcnt lgkmcnt(0)
    v_mfma_f32_32x32x16_bf16 v[96:111], v[240:243], v[248:251], v[96:111]
    v_mfma_f32_32x32x16_bf16 v[112:127], v[240:243], v[252:255], v[112:127]
    v_mfma_f32_32x32x16_bf16 v[128:143], v[244:247], v[248:251], v[128:143]
    v_mfma_f32_32x32x16_bf16 v[144:159], v[244:247], v[252:255], v[144:159]
    s_waitcnt vmcnt(8)
    ds_write_b128 v10, v[16:19] offset:0
    ds_write_b128 v10, v[20:23] offset:4608
    ds_write_b128 v10, v[24:27] offset:9216
    ds_write_b128 v10, v[28:31] offset:13824
    ds_write_b128 v10, v[32:35] offset:18432
    ds_write_b128 v10, v[36:39] offset:23040
    ds_write_b128 v10, v[40:43] offset:27648
    ds_write_b128 v10, v[44:47] offset:32256
    s_waitcnt lgkmcnt(0)
    s_barrier
    s_add_u32 s29, s25, 768
    s_add_u32 s30, s26, 768
    buffer_load_dwordx4 v[16:19], v6, s[12:15], s29 offen
    buffer_load_dwordx4 v[20:23], v7, s[12:15], s29 offen
    buffer_load_dwordx4 v[24:27], v8, s[12:15], s29 offen
    buffer_load_dwordx4 v[28:31], v9, s[12:15], s29 offen
    buffer_load_dwordx4 v[32:35], v6, s[12:15], s30 offen
    buffer_load_dwordx4 v[36:39], v7, s[12:15], s30 offen
    buffer_load_dwordx4 v[40:43], v8, s[12:15], s30 offen
    buffer_load_dwordx4 v[44:47], v9, s[12:15], s30 offen
    ds_read_b128 v[192:195], v14 offset:0
    ds_read_b128 v[196:199], v14 offset:4608
    ds_read_b128 v[200:203], v15 offset:0
    ds_read_b128 v[204:207], v15 offset:4608
    ds_read_b128 v[208:211], v14 offset:32
    ds_read_b128 v[212:215], v14 offset:4640
    ds_read_b128 v[216:219], v15 offset:32
    ds_read_b128 v[220:223], v15 offset:4640
    ds_read_b128 v[224:227], v14 offset:64
    ds_read_b128 v[228:231], v14 offset:4672
    ds_read_b128 v[232:235], v15 offset:64
    ds_read_b128 v[236:239], v15 offset:4672
    ds_read_b128 v[240:243], v14 offset:96
    ds_read_b128 v[244:247], v14 offset:4704
    ds_read_b128 v[248:251], v15 offset:96
    ds_read_b128 v[252:255], v15 offset:4704
    s_waitcnt lgkmcnt(12)
    v_mfma_f32_32x32x16_bf16 v[96:111], v[192:195], v[200:203], v[96:111]
    v_mfma_f32_32x32x16_bf16 v[112:127], v[192:195], v[204:207], v[112:127]
    v_mfma_f32_32x32x16_bf16 v[128:143], v[196:199], v[200:203], v[128:143]
    v_mfma_f32_32x32x16_bf16 v[144:159], v[196:199], v[204:207], v[144:159]
    s_waitcnt lgkmcnt(8)
    v_mfma_f32_32x32x16_bf16 v[96:111], v[208:211], v[216:219], v[96:111]
    v_mfma_f32_32x32x16_bf16 v[112:127], v[208:211], v[220:223], v[112:127]
    v_mfma_f32_32x32x16_bf16 v[128:143], v[212:215], v[216:219], v[128:143]
    v_mfma_f32_32x32x16_bf16 v[144:159], v[212:215], v[220:223], v[144:159]
    s_waitcnt lgkmcnt(4)
    v_mfma_f32_32x32x16_bf16 v[96:111], v[224:227], v[232:235], v[96:111]
    v_mfma_f32_32x32x16_bf16 v[112:127], v[224:227], v[236:239], v[112:127]
    v_mfma_f32_32x32x16_bf16 v[128:143], v[228:231], v[232:235], v[128:143]
    v_mfma_f32_32x32x16_bf16 v[144:159], v[228:231], v[236:239], v[144:159]
    s_waitcnt lgkmcnt(0)
    v_mfma_f32_32x32x16_bf16 v[96:111], v[240:243], v[248:251], v[96:111]
    v_mfma_f32_32x32x16_bf16 v[112:127], v[240:243], v[252:255], v[112:127]
    v_mfma_f32_32x32x16_bf16 v[128:143], v[244:247], v[248:251], v[128:143]
    v_mfma_f32_32x32x16_bf16 v[144:159], v[244:247], v[252:255], v[144:159]
    s_waitcnt vmcnt(8)
    ds_write_b128 v80, v[160:163] offset:0
    ds_write_b128 v80, v[164:167] offset:4608
    ds_write_b128 v80, v[168:171] offset:9216
    ds_write_b128 v80, v[172:175] offset:13824
    ds_write_b128 v80, v[176:179] offset:18432
    ds_write_b128 v80, v[180:183] offset:23040
    ds_write_b128 v80, v[184:187] offset:27648
    ds_write_b128 v80, v[188:191] offset:32256
    s_waitcnt lgkmcnt(0)
    s_barrier
    ds_read_b128 v[192:195], v14 offset:36864
    ds_read_b128 v[196:199], v14 offset:41472
    ds_read_b128 v[200:203], v15 offset:36864
    ds_read_b128 v[204:207], v15 offset:41472
    ds_read_b128 v[208:211], v14 offset:36896
    ds_read_b128 v[212:215], v14 offset:41504
    ds_read_b128 v[216:219], v15 offset:36896
    ds_read_b128 v[220:223], v15 offset:41504
    ds_read_b128 v[224:227], v14 offset:36928
    ds_read_b128 v[228:231], v14 offset:41536
    ds_read_b128 v[232:235], v15 offset:36928
    ds_read_b128 v[236:239], v15 offset:41536
    ds_read_b128 v[240:243], v14 offset:36960
    ds_read_b128 v[244:247], v14 offset:41568
    ds_read_b128 v[248:251], v15 offset:36960
    ds_read_b128 v[252:255], v15 offset:41568
    s_waitcnt lgkmcnt(12)
    v_mfma_f32_32x32x16_bf16 v[96:111], v[192:195], v[200:203], v[96:111]
    v_mfma_f32_32x32x16_bf16 v[112:127], v[192:195], v[204:207], v[112:127]
    v_mfma_f32_32x32x16_bf16 v[128:143], v[196:199], v[200:203], v[128:143]
    v_mfma_f32_32x32x16_bf16 v[144:159], v[196:199], v[204:207], v[144:159]
    s_waitcnt lgkmcnt(8)
    v_mfma_f32_32x32x16_bf16 v[96:111], v[208:211], v[216:219], v[96:111]
    v_mfma_f32_32x32x16_bf16 v[112:127], v[208:211], v[220:223], v[112:127]
    v_mfma_f32_32x32x16_bf16 v[128:143], v[212:215], v[216:219], v[128:143]
    v_mfma_f32_32x32x16_bf16 v[144:159], v[212:215], v[220:223], v[144:159]
    s_waitcnt lgkmcnt(4)
    v_mfma_f32_32x32x16_bf16 v[96:111], v[224:227], v[232:235], v[96:111]
    v_mfma_f32_32x32x16_bf16 v[112:127], v[224:227], v[236:239], v[112:127]
    v_mfma_f32_32x32x16_bf16 v[128:143], v[228:231], v[232:235], v[128:143]
    v_mfma_f32_32x32x16_bf16 v[144:159], v[228:231], v[236:239], v[144:159]
    s_waitcnt lgkmcnt(0)
    v_mfma_f32_32x32x16_bf16 v[96:111], v[240:243], v[248:251], v[96:111]
    v_mfma_f32_32x32x16_bf16 v[112:127], v[240:243], v[252:255], v[112:127]
    v_mfma_f32_32x32x16_bf16 v[128:143], v[244:247], v[248:251], v[128:143]
    v_mfma_f32_32x32x16_bf16 v[144:159], v[244:247], v[252:255], v[144:159]
    s_waitcnt vmcnt(0)
    ds_write_b128 v10, v[16:19] offset:0
    ds_write_b128 v10, v[20:23] offset:4608
    ds_write_b128 v10, v[24:27] offset:9216
    ds_write_b128 v10, v[28:31] offset:13824
    ds_write_b128 v10, v[32:35] offset:18432
    ds_write_b128 v10, v[36:39] offset:23040
    ds_write_b128 v10, v[40:43] offset:27648
    ds_write_b128 v10, v[44:47] offset:32256
    s_waitcnt lgkmcnt(0)
    s_barrier
    ds_read_b128 v[192:195], v14 offset:0
    ds_read_b128 v[196:199], v14 offset:4608
    ds_read_b128 v[200:203], v15 offset:0
    ds_read_b128 v[204:207], v15 offset:4608
    ds_read_b128 v[208:211], v14 offset:32
    ds_read_b128 v[212:215], v14 offset:4640
    ds_read_b128 v[216:219], v15 offset:32
    ds_read_b128 v[220:223], v15 offset:4640
    ds_read_b128 v[224:227], v14 offset:64
    ds_read_b128 v[228:231], v14 offset:4672
    ds_read_b128 v[232:235], v15 offset:64
    ds_read_b128 v[236:239], v15 offset:4672
    ds_read_b128 v[240:243], v14 offset:96
    ds_read_b128 v[244:247], v14 offset:4704
    ds_read_b128 v[248:251], v15 offset:96
    ds_read_b128 v[252:255], v15 offset:4704
    s_waitcnt lgkmcnt(12)
    v_mfma_f32_32x32x16_bf16 v[96:111], v[192:195], v[200:203], v[96:111]
    v_mfma_f32_32x32x16_bf16 v[112:127], v[192:195], v[204:207], v[112:127]
    v_mfma_f32_32x32x16_bf16 v[128:143], v[196:199], v[200:203], v[128:143]
    v_mfma_f32_32x32x16_bf16 v[144:159], v[196:199], v[204:207], v[144:159]
    s_waitcnt lgkmcnt(8)
    v_mfma_f32_32x32x16_bf16 v[96:111], v[208:211], v[216:219], v[96:111]
    v_mfma_f32_32x32x16_bf16 v[112:127], v[208:211], v[220:223], v[112:127]
    v_mfma_f32_32x32x16_bf16 v[128:143], v[212:215], v[216:219], v[128:143]
    v_mfma_f32_32x32x16_bf16 v[144:159], v[212:215], v[220:223], v[144:159]
    s_waitcnt lgkmcnt(4)
    v_mfma_f32_32x32x16_bf16 v[96:111], v[224:227], v[232:235], v[96:111]
    v_mfma_f32_32x32x16_bf16 v[112:127], v[224:227], v[236:239], v[112:127]
    v_mfma_f32_32x32x16_bf16 v[128:143], v[228:231], v[232:235], v[128:143]
    v_mfma_f32_32x32x16_bf16 v[144:159], v[228:231], v[236:239], v[144:159]
    s_waitcnt lgkmcnt(0)
    v_mfma_f32_32x32x16_bf16 v[96:111], v[240:243], v[248:251], v[96:111]
    v_mfma_f32_32x32x16_bf16 v[112:127], v[240:243], v[252:255], v[112:127]
    v_mfma_f32_32x32x16_bf16 v[128:143], v[244:247], v[248:251], v[128:143]
    v_mfma_f32_32x32x16_bf16 v[144:159], v[244:247], v[252:255], v[144:159]
    s_waitcnt lgkmcnt(0)
    s_barrier
    s_nop 15
    s_nop 15
    s_lshl_b32 s29, s21, 7
    s_lshl_b32 s30, s24, 6
    s_add_u32 s29, s29, s30
    v_add_u32 v16, s29, v11
    v_lshlrev_b32 v16, 1, v16
    buffer_load_ushort v17, v16, s[8:11], 0 offen
    buffer_load_ushort v18, v16, s[8:11], 0 offen offset:64
    s_lshl_b32 s29, s20, 7
    s_lshl_b32 s30, s23, 6
    s_add_u32 s29, s29, s30
    v_lshlrev_b32 v19, 2, v12
    v_add_u32 v19, s29, v19
    v_mul_u32_u24 v19, 3584, v19
    v_add_u32 v19, v19, v16
    v_add_u32 v19, 16777216, v19
    s_waitcnt vmcnt(0)
    v_lshlrev_b32 v17, 16, v17
    v_lshlrev_b32 v18, 16, v18
    v_cvt_pk_bf16_f32 v20, v96, v96
    v_lshlrev_b32 v20, 16, v20
    v_add_f32 v20, v20, v17
    v_cvt_pk_bf16_f32 v20, v20, v20
    v_lshlrev_b32 v20, 16, v20
    v_max_f32 v20, 0, v20
    v_mul_f32 v20, v20, v20
    v_cvt_pk_bf16_f32 v96, v20, v20
    s_mov_b32 s29, 0
    buffer_store_short v96, v19, s[12:15], s29 offen
    v_cvt_pk_bf16_f32 v20, v97, v97
    v_lshlrev_b32 v20, 16, v20
    v_add_f32 v20, v20, v17
    v_cvt_pk_bf16_f32 v20, v20, v20
    v_lshlrev_b32 v20, 16, v20
    v_max_f32 v20, 0, v20
    v_mul_f32 v20, v20, v20
    v_cvt_pk_bf16_f32 v97, v20, v20
    s_mov_b32 s29, 3584
    buffer_store_short v97, v19, s[12:15], s29 offen
    v_cvt_pk_bf16_f32 v20, v98, v98
    v_lshlrev_b32 v20, 16, v20
    v_add_f32 v20, v20, v17
    v_cvt_pk_bf16_f32 v20, v20, v20
    v_lshlrev_b32 v20, 16, v20
    v_max_f32 v20, 0, v20
    v_mul_f32 v20, v20, v20
    v_cvt_pk_bf16_f32 v98, v20, v20
    s_mov_b32 s29, 7168
    buffer_store_short v98, v19, s[12:15], s29 offen
    v_cvt_pk_bf16_f32 v20, v99, v99
    v_lshlrev_b32 v20, 16, v20
    v_add_f32 v20, v20, v17
    v_cvt_pk_bf16_f32 v20, v20, v20
    v_lshlrev_b32 v20, 16, v20
    v_max_f32 v20, 0, v20
    v_mul_f32 v20, v20, v20
    v_cvt_pk_bf16_f32 v99, v20, v20
    s_mov_b32 s29, 10752
    buffer_store_short v99, v19, s[12:15], s29 offen
    v_cvt_pk_bf16_f32 v20, v100, v100
    v_lshlrev_b32 v20, 16, v20
    v_add_f32 v20, v20, v17
    v_cvt_pk_bf16_f32 v20, v20, v20
    v_lshlrev_b32 v20, 16, v20
    v_max_f32 v20, 0, v20
    v_mul_f32 v20, v20, v20
    v_cvt_pk_bf16_f32 v100, v20, v20
    s_mov_b32 s29, 28672
    buffer_store_short v100, v19, s[12:15], s29 offen
    v_cvt_pk_bf16_f32 v20, v101, v101
    v_lshlrev_b32 v20, 16, v20
    v_add_f32 v20, v20, v17
    v_cvt_pk_bf16_f32 v20, v20, v20
    v_lshlrev_b32 v20, 16, v20
    v_max_f32 v20, 0, v20
    v_mul_f32 v20, v20, v20
    v_cvt_pk_bf16_f32 v101, v20, v20
    s_mov_b32 s29, 32256
    buffer_store_short v101, v19, s[12:15], s29 offen
    v_cvt_pk_bf16_f32 v20, v102, v102
    v_lshlrev_b32 v20, 16, v20
    v_add_f32 v20, v20, v17
    v_cvt_pk_bf16_f32 v20, v20, v20
    v_lshlrev_b32 v20, 16, v20
    v_max_f32 v20, 0, v20
    v_mul_f32 v20, v20, v20
    v_cvt_pk_bf16_f32 v102, v20, v20
    s_mov_b32 s29, 35840
    buffer_store_short v102, v19, s[12:15], s29 offen
    v_cvt_pk_bf16_f32 v20, v103, v103
    v_lshlrev_b32 v20, 16, v20
    v_add_f32 v20, v20, v17
    v_cvt_pk_bf16_f32 v20, v20, v20
    v_lshlrev_b32 v20, 16, v20
    v_max_f32 v20, 0, v20
    v_mul_f32 v20, v20, v20
    v_cvt_pk_bf16_f32 v103, v20, v20
    s_mov_b32 s29, 39424
    buffer_store_short v103, v19, s[12:15], s29 offen
    v_cvt_pk_bf16_f32 v20, v104, v104
    v_lshlrev_b32 v20, 16, v20
    v_add_f32 v20, v20, v17
    v_cvt_pk_bf16_f32 v20, v20, v20
    v_lshlrev_b32 v20, 16, v20
    v_max_f32 v20, 0, v20
    v_mul_f32 v20, v20, v20
    v_cvt_pk_bf16_f32 v104, v20, v20
    s_mov_b32 s29, 57344
    buffer_store_short v104, v19, s[12:15], s29 offen
    v_cvt_pk_bf16_f32 v20, v105, v105
    v_lshlrev_b32 v20, 16, v20
    v_add_f32 v20, v20, v17
    v_cvt_pk_bf16_f32 v20, v20, v20
    v_lshlrev_b32 v20, 16, v20
    v_max_f32 v20, 0, v20
    v_mul_f32 v20, v20, v20
    v_cvt_pk_bf16_f32 v105, v20, v20
    s_mov_b32 s29, 60928
    buffer_store_short v105, v19, s[12:15], s29 offen
    v_cvt_pk_bf16_f32 v20, v106, v106
    v_lshlrev_b32 v20, 16, v20
    v_add_f32 v20, v20, v17
    v_cvt_pk_bf16_f32 v20, v20, v20
    v_lshlrev_b32 v20, 16, v20
    v_max_f32 v20, 0, v20
    v_mul_f32 v20, v20, v20
    v_cvt_pk_bf16_f32 v106, v20, v20
    s_mov_b32 s29, 64512
    buffer_store_short v106, v19, s[12:15], s29 offen
    v_cvt_pk_bf16_f32 v20, v107, v107
    v_lshlrev_b32 v20, 16, v20
    v_add_f32 v20, v20, v17
    v_cvt_pk_bf16_f32 v20, v20, v20
    v_lshlrev_b32 v20, 16, v20
    v_max_f32 v20, 0, v20
    v_mul_f32 v20, v20, v20
    v_cvt_pk_bf16_f32 v107, v20, v20
    s_mov_b32 s29, 68096
    buffer_store_short v107, v19, s[12:15], s29 offen
    v_cvt_pk_bf16_f32 v20, v108, v108
    v_lshlrev_b32 v20, 16, v20
    v_add_f32 v20, v20, v17
    v_cvt_pk_bf16_f32 v20, v20, v20
    v_lshlrev_b32 v20, 16, v20
    v_max_f32 v20, 0, v20
    v_mul_f32 v20, v20, v20
    v_cvt_pk_bf16_f32 v108, v20, v20
    s_mov_b32 s29, 86016
    buffer_store_short v108, v19, s[12:15], s29 offen
    v_cvt_pk_bf16_f32 v20, v109, v109
    v_lshlrev_b32 v20, 16, v20
    v_add_f32 v20, v20, v17
    v_cvt_pk_bf16_f32 v20, v20, v20
    v_lshlrev_b32 v20, 16, v20
    v_max_f32 v20, 0, v20
    v_mul_f32 v20, v20, v20
    v_cvt_pk_bf16_f32 v109, v20, v20
    s_mov_b32 s29, 89600
    buffer_store_short v109, v19, s[12:15], s29 offen
    v_cvt_pk_bf16_f32 v20, v110, v110
    v_lshlrev_b32 v20, 16, v20
    v_add_f32 v20, v20, v17
    v_cvt_pk_bf16_f32 v20, v20, v20
    v_lshlrev_b32 v20, 16, v20
    v_max_f32 v20, 0, v20
    v_mul_f32 v20, v20, v20
    v_cvt_pk_bf16_f32 v110, v20, v20
    s_mov_b32 s29, 93184
    buffer_store_short v110, v19, s[12:15], s29 offen
    v_cvt_pk_bf16_f32 v20, v111, v111
    v_lshlrev_b32 v20, 16, v20
    v_add_f32 v20, v20, v17
    v_cvt_pk_bf16_f32 v20, v20, v20
    v_lshlrev_b32 v20, 16, v20
    v_max_f32 v20, 0, v20
    v_mul_f32 v20, v20, v20
    v_cvt_pk_bf16_f32 v111, v20, v20
    s_mov_b32 s29, 96768
    buffer_store_short v111, v19, s[12:15], s29 offen
    v_cvt_pk_bf16_f32 v20, v112, v112
    v_lshlrev_b32 v20, 16, v20
    v_add_f32 v20, v20, v18
    v_cvt_pk_bf16_f32 v20, v20, v20
    v_lshlrev_b32 v20, 16, v20
    v_max_f32 v20, 0, v20
    v_mul_f32 v20, v20, v20
    v_cvt_pk_bf16_f32 v112, v20, v20
    s_mov_b32 s29, 64
    buffer_store_short v112, v19, s[12:15], s29 offen
    v_cvt_pk_bf16_f32 v20, v113, v113
    v_lshlrev_b32 v20, 16, v20
    v_add_f32 v20, v20, v18
    v_cvt_pk_bf16_f32 v20, v20, v20
    v_lshlrev_b32 v20, 16, v20
    v_max_f32 v20, 0, v20
    v_mul_f32 v20, v20, v20
    v_cvt_pk_bf16_f32 v113, v20, v20
    s_mov_b32 s29, 3648
    buffer_store_short v113, v19, s[12:15], s29 offen
    v_cvt_pk_bf16_f32 v20, v114, v114
    v_lshlrev_b32 v20, 16, v20
    v_add_f32 v20, v20, v18
    v_cvt_pk_bf16_f32 v20, v20, v20
    v_lshlrev_b32 v20, 16, v20
    v_max_f32 v20, 0, v20
    v_mul_f32 v20, v20, v20
    v_cvt_pk_bf16_f32 v114, v20, v20
    s_mov_b32 s29, 7232
    buffer_store_short v114, v19, s[12:15], s29 offen
    v_cvt_pk_bf16_f32 v20, v115, v115
    v_lshlrev_b32 v20, 16, v20
    v_add_f32 v20, v20, v18
    v_cvt_pk_bf16_f32 v20, v20, v20
    v_lshlrev_b32 v20, 16, v20
    v_max_f32 v20, 0, v20
    v_mul_f32 v20, v20, v20
    v_cvt_pk_bf16_f32 v115, v20, v20
    s_mov_b32 s29, 10816
    buffer_store_short v115, v19, s[12:15], s29 offen
    v_cvt_pk_bf16_f32 v20, v116, v116
    v_lshlrev_b32 v20, 16, v20
    v_add_f32 v20, v20, v18
    v_cvt_pk_bf16_f32 v20, v20, v20
    v_lshlrev_b32 v20, 16, v20
    v_max_f32 v20, 0, v20
    v_mul_f32 v20, v20, v20
    v_cvt_pk_bf16_f32 v116, v20, v20
    s_mov_b32 s29, 28736
    buffer_store_short v116, v19, s[12:15], s29 offen
    v_cvt_pk_bf16_f32 v20, v117, v117
    v_lshlrev_b32 v20, 16, v20
    v_add_f32 v20, v20, v18
    v_cvt_pk_bf16_f32 v20, v20, v20
    v_lshlrev_b32 v20, 16, v20
    v_max_f32 v20, 0, v20
    v_mul_f32 v20, v20, v20
    v_cvt_pk_bf16_f32 v117, v20, v20
    s_mov_b32 s29, 32320
    buffer_store_short v117, v19, s[12:15], s29 offen
    v_cvt_pk_bf16_f32 v20, v118, v118
    v_lshlrev_b32 v20, 16, v20
    v_add_f32 v20, v20, v18
    v_cvt_pk_bf16_f32 v20, v20, v20
    v_lshlrev_b32 v20, 16, v20
    v_max_f32 v20, 0, v20
    v_mul_f32 v20, v20, v20
    v_cvt_pk_bf16_f32 v118, v20, v20
    s_mov_b32 s29, 35904
    buffer_store_short v118, v19, s[12:15], s29 offen
    v_cvt_pk_bf16_f32 v20, v119, v119
    v_lshlrev_b32 v20, 16, v20
    v_add_f32 v20, v20, v18
    v_cvt_pk_bf16_f32 v20, v20, v20
    v_lshlrev_b32 v20, 16, v20
    v_max_f32 v20, 0, v20
    v_mul_f32 v20, v20, v20
    v_cvt_pk_bf16_f32 v119, v20, v20
    s_mov_b32 s29, 39488
    buffer_store_short v119, v19, s[12:15], s29 offen
    v_cvt_pk_bf16_f32 v20, v120, v120
    v_lshlrev_b32 v20, 16, v20
    v_add_f32 v20, v20, v18
    v_cvt_pk_bf16_f32 v20, v20, v20
    v_lshlrev_b32 v20, 16, v20
    v_max_f32 v20, 0, v20
    v_mul_f32 v20, v20, v20
    v_cvt_pk_bf16_f32 v120, v20, v20
    s_mov_b32 s29, 57408
    buffer_store_short v120, v19, s[12:15], s29 offen
    v_cvt_pk_bf16_f32 v20, v121, v121
    v_lshlrev_b32 v20, 16, v20
    v_add_f32 v20, v20, v18
    v_cvt_pk_bf16_f32 v20, v20, v20
    v_lshlrev_b32 v20, 16, v20
    v_max_f32 v20, 0, v20
    v_mul_f32 v20, v20, v20
    v_cvt_pk_bf16_f32 v121, v20, v20
    s_mov_b32 s29, 60992
    buffer_store_short v121, v19, s[12:15], s29 offen
    v_cvt_pk_bf16_f32 v20, v122, v122
    v_lshlrev_b32 v20, 16, v20
    v_add_f32 v20, v20, v18
    v_cvt_pk_bf16_f32 v20, v20, v20
    v_lshlrev_b32 v20, 16, v20
    v_max_f32 v20, 0, v20
    v_mul_f32 v20, v20, v20
    v_cvt_pk_bf16_f32 v122, v20, v20
    s_mov_b32 s29, 64576
    buffer_store_short v122, v19, s[12:15], s29 offen
    v_cvt_pk_bf16_f32 v20, v123, v123
    v_lshlrev_b32 v20, 16, v20
    v_add_f32 v20, v20, v18
    v_cvt_pk_bf16_f32 v20, v20, v20
    v_lshlrev_b32 v20, 16, v20
    v_max_f32 v20, 0, v20
    v_mul_f32 v20, v20, v20
    v_cvt_pk_bf16_f32 v123, v20, v20
    s_mov_b32 s29, 68160
    buffer_store_short v123, v19, s[12:15], s29 offen
    v_cvt_pk_bf16_f32 v20, v124, v124
    v_lshlrev_b32 v20, 16, v20
    v_add_f32 v20, v20, v18
    v_cvt_pk_bf16_f32 v20, v20, v20
    v_lshlrev_b32 v20, 16, v20
    v_max_f32 v20, 0, v20
    v_mul_f32 v20, v20, v20
    v_cvt_pk_bf16_f32 v124, v20, v20
    s_mov_b32 s29, 86080
    buffer_store_short v124, v19, s[12:15], s29 offen
    v_cvt_pk_bf16_f32 v20, v125, v125
    v_lshlrev_b32 v20, 16, v20
    v_add_f32 v20, v20, v18
    v_cvt_pk_bf16_f32 v20, v20, v20
    v_lshlrev_b32 v20, 16, v20
    v_max_f32 v20, 0, v20
    v_mul_f32 v20, v20, v20
    v_cvt_pk_bf16_f32 v125, v20, v20
    s_mov_b32 s29, 89664
    buffer_store_short v125, v19, s[12:15], s29 offen
    v_cvt_pk_bf16_f32 v20, v126, v126
    v_lshlrev_b32 v20, 16, v20
    v_add_f32 v20, v20, v18
    v_cvt_pk_bf16_f32 v20, v20, v20
    v_lshlrev_b32 v20, 16, v20
    v_max_f32 v20, 0, v20
    v_mul_f32 v20, v20, v20
    v_cvt_pk_bf16_f32 v126, v20, v20
    s_mov_b32 s29, 93248
    buffer_store_short v126, v19, s[12:15], s29 offen
    v_cvt_pk_bf16_f32 v20, v127, v127
    v_lshlrev_b32 v20, 16, v20
    v_add_f32 v20, v20, v18
    v_cvt_pk_bf16_f32 v20, v20, v20
    v_lshlrev_b32 v20, 16, v20
    v_max_f32 v20, 0, v20
    v_mul_f32 v20, v20, v20
    v_cvt_pk_bf16_f32 v127, v20, v20
    s_mov_b32 s29, 96832
    buffer_store_short v127, v19, s[12:15], s29 offen
    v_cvt_pk_bf16_f32 v20, v128, v128
    v_lshlrev_b32 v20, 16, v20
    v_add_f32 v20, v20, v17
    v_cvt_pk_bf16_f32 v20, v20, v20
    v_lshlrev_b32 v20, 16, v20
    v_max_f32 v20, 0, v20
    v_mul_f32 v20, v20, v20
    v_cvt_pk_bf16_f32 v128, v20, v20
    s_mov_b32 s29, 114688
    buffer_store_short v128, v19, s[12:15], s29 offen
    v_cvt_pk_bf16_f32 v20, v129, v129
    v_lshlrev_b32 v20, 16, v20
    v_add_f32 v20, v20, v17
    v_cvt_pk_bf16_f32 v20, v20, v20
    v_lshlrev_b32 v20, 16, v20
    v_max_f32 v20, 0, v20
    v_mul_f32 v20, v20, v20
    v_cvt_pk_bf16_f32 v129, v20, v20
    s_mov_b32 s29, 118272
    buffer_store_short v129, v19, s[12:15], s29 offen
    v_cvt_pk_bf16_f32 v20, v130, v130
    v_lshlrev_b32 v20, 16, v20
    v_add_f32 v20, v20, v17
    v_cvt_pk_bf16_f32 v20, v20, v20
    v_lshlrev_b32 v20, 16, v20
    v_max_f32 v20, 0, v20
    v_mul_f32 v20, v20, v20
    v_cvt_pk_bf16_f32 v130, v20, v20
    s_mov_b32 s29, 121856
    buffer_store_short v130, v19, s[12:15], s29 offen
    v_cvt_pk_bf16_f32 v20, v131, v131
    v_lshlrev_b32 v20, 16, v20
    v_add_f32 v20, v20, v17
    v_cvt_pk_bf16_f32 v20, v20, v20
    v_lshlrev_b32 v20, 16, v20
    v_max_f32 v20, 0, v20
    v_mul_f32 v20, v20, v20
    v_cvt_pk_bf16_f32 v131, v20, v20
    s_mov_b32 s29, 125440
    buffer_store_short v131, v19, s[12:15], s29 offen
    v_cvt_pk_bf16_f32 v20, v132, v132
    v_lshlrev_b32 v20, 16, v20
    v_add_f32 v20, v20, v17
    v_cvt_pk_bf16_f32 v20, v20, v20
    v_lshlrev_b32 v20, 16, v20
    v_max_f32 v20, 0, v20
    v_mul_f32 v20, v20, v20
    v_cvt_pk_bf16_f32 v132, v20, v20
    s_mov_b32 s29, 143360
    buffer_store_short v132, v19, s[12:15], s29 offen
    v_cvt_pk_bf16_f32 v20, v133, v133
    v_lshlrev_b32 v20, 16, v20
    v_add_f32 v20, v20, v17
    v_cvt_pk_bf16_f32 v20, v20, v20
    v_lshlrev_b32 v20, 16, v20
    v_max_f32 v20, 0, v20
    v_mul_f32 v20, v20, v20
    v_cvt_pk_bf16_f32 v133, v20, v20
    s_mov_b32 s29, 146944
    buffer_store_short v133, v19, s[12:15], s29 offen
    v_cvt_pk_bf16_f32 v20, v134, v134
    v_lshlrev_b32 v20, 16, v20
    v_add_f32 v20, v20, v17
    v_cvt_pk_bf16_f32 v20, v20, v20
    v_lshlrev_b32 v20, 16, v20
    v_max_f32 v20, 0, v20
    v_mul_f32 v20, v20, v20
    v_cvt_pk_bf16_f32 v134, v20, v20
    s_mov_b32 s29, 150528
    buffer_store_short v134, v19, s[12:15], s29 offen
    v_cvt_pk_bf16_f32 v20, v135, v135
    v_lshlrev_b32 v20, 16, v20
    v_add_f32 v20, v20, v17
    v_cvt_pk_bf16_f32 v20, v20, v20
    v_lshlrev_b32 v20, 16, v20
    v_max_f32 v20, 0, v20
    v_mul_f32 v20, v20, v20
    v_cvt_pk_bf16_f32 v135, v20, v20
    s_mov_b32 s29, 154112
    buffer_store_short v135, v19, s[12:15], s29 offen
    v_cvt_pk_bf16_f32 v20, v136, v136
    v_lshlrev_b32 v20, 16, v20
    v_add_f32 v20, v20, v17
    v_cvt_pk_bf16_f32 v20, v20, v20
    v_lshlrev_b32 v20, 16, v20
    v_max_f32 v20, 0, v20
    v_mul_f32 v20, v20, v20
    v_cvt_pk_bf16_f32 v136, v20, v20
    s_mov_b32 s29, 172032
    buffer_store_short v136, v19, s[12:15], s29 offen
    v_cvt_pk_bf16_f32 v20, v137, v137
    v_lshlrev_b32 v20, 16, v20
    v_add_f32 v20, v20, v17
    v_cvt_pk_bf16_f32 v20, v20, v20
    v_lshlrev_b32 v20, 16, v20
    v_max_f32 v20, 0, v20
    v_mul_f32 v20, v20, v20
    v_cvt_pk_bf16_f32 v137, v20, v20
    s_mov_b32 s29, 175616
    buffer_store_short v137, v19, s[12:15], s29 offen
    v_cvt_pk_bf16_f32 v20, v138, v138
    v_lshlrev_b32 v20, 16, v20
    v_add_f32 v20, v20, v17
    v_cvt_pk_bf16_f32 v20, v20, v20
    v_lshlrev_b32 v20, 16, v20
    v_max_f32 v20, 0, v20
    v_mul_f32 v20, v20, v20
    v_cvt_pk_bf16_f32 v138, v20, v20
    s_mov_b32 s29, 179200
    buffer_store_short v138, v19, s[12:15], s29 offen
    v_cvt_pk_bf16_f32 v20, v139, v139
    v_lshlrev_b32 v20, 16, v20
    v_add_f32 v20, v20, v17
    v_cvt_pk_bf16_f32 v20, v20, v20
    v_lshlrev_b32 v20, 16, v20
    v_max_f32 v20, 0, v20
    v_mul_f32 v20, v20, v20
    v_cvt_pk_bf16_f32 v139, v20, v20
    s_mov_b32 s29, 182784
    buffer_store_short v139, v19, s[12:15], s29 offen
    v_cvt_pk_bf16_f32 v20, v140, v140
    v_lshlrev_b32 v20, 16, v20
    v_add_f32 v20, v20, v17
    v_cvt_pk_bf16_f32 v20, v20, v20
    v_lshlrev_b32 v20, 16, v20
    v_max_f32 v20, 0, v20
    v_mul_f32 v20, v20, v20
    v_cvt_pk_bf16_f32 v140, v20, v20
    s_mov_b32 s29, 200704
    buffer_store_short v140, v19, s[12:15], s29 offen
    v_cvt_pk_bf16_f32 v20, v141, v141
    v_lshlrev_b32 v20, 16, v20
    v_add_f32 v20, v20, v17
    v_cvt_pk_bf16_f32 v20, v20, v20
    v_lshlrev_b32 v20, 16, v20
    v_max_f32 v20, 0, v20
    v_mul_f32 v20, v20, v20
    v_cvt_pk_bf16_f32 v141, v20, v20
    s_mov_b32 s29, 204288
    buffer_store_short v141, v19, s[12:15], s29 offen
    v_cvt_pk_bf16_f32 v20, v142, v142
    v_lshlrev_b32 v20, 16, v20
    v_add_f32 v20, v20, v17
    v_cvt_pk_bf16_f32 v20, v20, v20
    v_lshlrev_b32 v20, 16, v20
    v_max_f32 v20, 0, v20
    v_mul_f32 v20, v20, v20
    v_cvt_pk_bf16_f32 v142, v20, v20
    s_mov_b32 s29, 207872
    buffer_store_short v142, v19, s[12:15], s29 offen
    v_cvt_pk_bf16_f32 v20, v143, v143
    v_lshlrev_b32 v20, 16, v20
    v_add_f32 v20, v20, v17
    v_cvt_pk_bf16_f32 v20, v20, v20
    v_lshlrev_b32 v20, 16, v20
    v_max_f32 v20, 0, v20
    v_mul_f32 v20, v20, v20
    v_cvt_pk_bf16_f32 v143, v20, v20
    s_mov_b32 s29, 211456
    buffer_store_short v143, v19, s[12:15], s29 offen
    v_cvt_pk_bf16_f32 v20, v144, v144
    v_lshlrev_b32 v20, 16, v20
    v_add_f32 v20, v20, v18
    v_cvt_pk_bf16_f32 v20, v20, v20
    v_lshlrev_b32 v20, 16, v20
    v_max_f32 v20, 0, v20
    v_mul_f32 v20, v20, v20
    v_cvt_pk_bf16_f32 v144, v20, v20
    s_mov_b32 s29, 114752
    buffer_store_short v144, v19, s[12:15], s29 offen
    v_cvt_pk_bf16_f32 v20, v145, v145
    v_lshlrev_b32 v20, 16, v20
    v_add_f32 v20, v20, v18
    v_cvt_pk_bf16_f32 v20, v20, v20
    v_lshlrev_b32 v20, 16, v20
    v_max_f32 v20, 0, v20
    v_mul_f32 v20, v20, v20
    v_cvt_pk_bf16_f32 v145, v20, v20
    s_mov_b32 s29, 118336
    buffer_store_short v145, v19, s[12:15], s29 offen
    v_cvt_pk_bf16_f32 v20, v146, v146
    v_lshlrev_b32 v20, 16, v20
    v_add_f32 v20, v20, v18
    v_cvt_pk_bf16_f32 v20, v20, v20
    v_lshlrev_b32 v20, 16, v20
    v_max_f32 v20, 0, v20
    v_mul_f32 v20, v20, v20
    v_cvt_pk_bf16_f32 v146, v20, v20
    s_mov_b32 s29, 121920
    buffer_store_short v146, v19, s[12:15], s29 offen
    v_cvt_pk_bf16_f32 v20, v147, v147
    v_lshlrev_b32 v20, 16, v20
    v_add_f32 v20, v20, v18
    v_cvt_pk_bf16_f32 v20, v20, v20
    v_lshlrev_b32 v20, 16, v20
    v_max_f32 v20, 0, v20
    v_mul_f32 v20, v20, v20
    v_cvt_pk_bf16_f32 v147, v20, v20
    s_mov_b32 s29, 125504
    buffer_store_short v147, v19, s[12:15], s29 offen
    v_cvt_pk_bf16_f32 v20, v148, v148
    v_lshlrev_b32 v20, 16, v20
    v_add_f32 v20, v20, v18
    v_cvt_pk_bf16_f32 v20, v20, v20
    v_lshlrev_b32 v20, 16, v20
    v_max_f32 v20, 0, v20
    v_mul_f32 v20, v20, v20
    v_cvt_pk_bf16_f32 v148, v20, v20
    s_mov_b32 s29, 143424
    buffer_store_short v148, v19, s[12:15], s29 offen
    v_cvt_pk_bf16_f32 v20, v149, v149
    v_lshlrev_b32 v20, 16, v20
    v_add_f32 v20, v20, v18
    v_cvt_pk_bf16_f32 v20, v20, v20
    v_lshlrev_b32 v20, 16, v20
    v_max_f32 v20, 0, v20
    v_mul_f32 v20, v20, v20
    v_cvt_pk_bf16_f32 v149, v20, v20
    s_mov_b32 s29, 147008
    buffer_store_short v149, v19, s[12:15], s29 offen
    v_cvt_pk_bf16_f32 v20, v150, v150
    v_lshlrev_b32 v20, 16, v20
    v_add_f32 v20, v20, v18
    v_cvt_pk_bf16_f32 v20, v20, v20
    v_lshlrev_b32 v20, 16, v20
    v_max_f32 v20, 0, v20
    v_mul_f32 v20, v20, v20
    v_cvt_pk_bf16_f32 v150, v20, v20
    s_mov_b32 s29, 150592
    buffer_store_short v150, v19, s[12:15], s29 offen
    v_cvt_pk_bf16_f32 v20, v151, v151
    v_lshlrev_b32 v20, 16, v20
    v_add_f32 v20, v20, v18
    v_cvt_pk_bf16_f32 v20, v20, v20
    v_lshlrev_b32 v20, 16, v20
    v_max_f32 v20, 0, v20
    v_mul_f32 v20, v20, v20
    v_cvt_pk_bf16_f32 v151, v20, v20
    s_mov_b32 s29, 154176
    buffer_store_short v151, v19, s[12:15], s29 offen
    v_cvt_pk_bf16_f32 v20, v152, v152
    v_lshlrev_b32 v20, 16, v20
    v_add_f32 v20, v20, v18
    v_cvt_pk_bf16_f32 v20, v20, v20
    v_lshlrev_b32 v20, 16, v20
    v_max_f32 v20, 0, v20
    v_mul_f32 v20, v20, v20
    v_cvt_pk_bf16_f32 v152, v20, v20
    s_mov_b32 s29, 172096
    buffer_store_short v152, v19, s[12:15], s29 offen
    v_cvt_pk_bf16_f32 v20, v153, v153
    v_lshlrev_b32 v20, 16, v20
    v_add_f32 v20, v20, v18
    v_cvt_pk_bf16_f32 v20, v20, v20
    v_lshlrev_b32 v20, 16, v20
    v_max_f32 v20, 0, v20
    v_mul_f32 v20, v20, v20
    v_cvt_pk_bf16_f32 v153, v20, v20
    s_mov_b32 s29, 175680
    buffer_store_short v153, v19, s[12:15], s29 offen
    v_cvt_pk_bf16_f32 v20, v154, v154
    v_lshlrev_b32 v20, 16, v20
    v_add_f32 v20, v20, v18
    v_cvt_pk_bf16_f32 v20, v20, v20
    v_lshlrev_b32 v20, 16, v20
    v_max_f32 v20, 0, v20
    v_mul_f32 v20, v20, v20
    v_cvt_pk_bf16_f32 v154, v20, v20
    s_mov_b32 s29, 179264
    buffer_store_short v154, v19, s[12:15], s29 offen
    v_cvt_pk_bf16_f32 v20, v155, v155
    v_lshlrev_b32 v20, 16, v20
    v_add_f32 v20, v20, v18
    v_cvt_pk_bf16_f32 v20, v20, v20
    v_lshlrev_b32 v20, 16, v20
    v_max_f32 v20, 0, v20
    v_mul_f32 v20, v20, v20
    v_cvt_pk_bf16_f32 v155, v20, v20
    s_mov_b32 s29, 182848
    buffer_store_short v155, v19, s[12:15], s29 offen
    v_cvt_pk_bf16_f32 v20, v156, v156
    v_lshlrev_b32 v20, 16, v20
    v_add_f32 v20, v20, v18
    v_cvt_pk_bf16_f32 v20, v20, v20
    v_lshlrev_b32 v20, 16, v20
    v_max_f32 v20, 0, v20
    v_mul_f32 v20, v20, v20
    v_cvt_pk_bf16_f32 v156, v20, v20
    s_mov_b32 s29, 200768
    buffer_store_short v156, v19, s[12:15], s29 offen
    v_cvt_pk_bf16_f32 v20, v157, v157
    v_lshlrev_b32 v20, 16, v20
    v_add_f32 v20, v20, v18
    v_cvt_pk_bf16_f32 v20, v20, v20
    v_lshlrev_b32 v20, 16, v20
    v_max_f32 v20, 0, v20
    v_mul_f32 v20, v20, v20
    v_cvt_pk_bf16_f32 v157, v20, v20
    s_mov_b32 s29, 204352
    buffer_store_short v157, v19, s[12:15], s29 offen
    v_cvt_pk_bf16_f32 v20, v158, v158
    v_lshlrev_b32 v20, 16, v20
    v_add_f32 v20, v20, v18
    v_cvt_pk_bf16_f32 v20, v20, v20
    v_lshlrev_b32 v20, 16, v20
    v_max_f32 v20, 0, v20
    v_mul_f32 v20, v20, v20
    v_cvt_pk_bf16_f32 v158, v20, v20
    s_mov_b32 s29, 207936
    buffer_store_short v158, v19, s[12:15], s29 offen
    v_cvt_pk_bf16_f32 v20, v159, v159
    v_lshlrev_b32 v20, 16, v20
    v_add_f32 v20, v20, v18
    v_cvt_pk_bf16_f32 v20, v20, v20
    v_lshlrev_b32 v20, 16, v20
    v_max_f32 v20, 0, v20
    v_mul_f32 v20, v20, v20
    v_cvt_pk_bf16_f32 v159, v20, v20
    s_mov_b32 s29, 211520
    buffer_store_short v159, v19, s[12:15], s29 offen
    s_endpgm
L_mid_kernel_r0:
    s_sub_u32 s3, s2, 224
    s_cmp_ge_u32 s3, 448
    s_cbranch_scc1 L_mid_kernel_r1
    s_load_dwordx2 s[6:7], s[0:1], 112
    v_and_b32 v1, 63, v0
    v_lshrrev_b32 v2, 6, v0
    s_nop 0
    v_readfirstlane_b32 s22, v2
    s_waitcnt lgkmcnt(0)
    s_mov_b32 s12, s6
    s_and_b32 s13, s7, 0xffff
    s_mov_b32 s14, 268435456
    s_mov_b32 s15, 0x00020000
    s_lshl_b32 s20, s3, 12
    s_add_u32 s20, s20, 2097152
    v_lshlrev_b32 v3, 4, v0
    buffer_load_dwordx4 v[40:43], v3, s[12:15], s20 offen
    s_mul_i32 s21, s3, 2816
    s_add_u32 s21, s21, 8388608
    v_lshlrev_b32 v4, 3, v0
    v_sub_u32 v4, 2047, v4
    v_mov_b32 v7, 0x7ff00000
    v_subrev_u32 v5, 0, v4
    v_cmp_gt_i32 vcc, 0, v5
    v_cvt_f32_u32 v8, v5
    v_cvt_pk_bf16_f32 v8, v8, v8
    v_lshlrev_b32 v8, 16, v8
    v_cvt_u32_f32 v6, v8
    v_lshrrev_b32 v8, 23, v8
    v_subrev_u32 v8, 134, v8
    v_max_i32 v8, 0, v8
    v_lshrrev_b32 v6, v8, v6
    v_lshl_add_u32 v6, v8, 7, v6
    v_lshlrev_b32 v6, 2, v6
    buffer_load_dword v96, v6, s[12:15], s21 offen
    v_subrev_u32 v5, 1, v4
    v_cmp_gt_i32 vcc, 0, v5
    v_cvt_f32_u32 v8, v5
    v_cvt_pk_bf16_f32 v8, v8, v8
    v_lshlrev_b32 v8, 16, v8
    v_cvt_u32_f32 v6, v8
    v_lshrrev_b32 v8, 23, v8
    v_subrev_u32 v8, 134, v8
    v_max_i32 v8, 0, v8
    v_lshrrev_b32 v6, v8, v6
    v_lshl_add_u32 v6, v8, 7, v6
    v_lshlrev_b32 v6, 2, v6
    buffer_load_dword v97, v6, s[12:15], s21 offen
    v_subrev_u32 v5, 2, v4
    v_cmp_gt_i32 vcc, 0, v5
    v_cvt_f32_u32 v8, v5
    v_cvt_pk_bf16_f32 v8, v8, v8
    v_lshlrev_b32 v8, 16, v8
    v_cvt_u32_f32 v6, v8
    v_lshrrev_b32 v8, 23, v8
    v_subrev_u32 v8, 134, v8
    v_max_i32 v8, 0, v8
    v_lshrrev_b32 v6, v8, v6
    v_lshl_add_u32 v6, v8, 7, v6
    v_lshlrev_b32 v6, 2, v6
    buffer_load_dword v98, v6, s[12:15], s21 offen
    v_subrev_u32 v5, 3, v4
    v_cmp_gt_i32 vcc, 0, v5
    v_cvt_f32_u32 v8, v5
    v_cvt_pk_bf16_f32 v8, v8, v8
    v_lshlrev_b32 v8, 16, v8
    v_cvt_u32_f32 v6, v8
    v_lshrrev_b32 v8, 23, v8
    v_subrev_u32 v8, 134, v8
    v_max_i32 v8, 0, v8
    v_lshrrev_b32 v6, v8, v6
    v_lshl_add_u32 v6, v8, 7, v6
    v_lshlrev_b32 v6, 2, v6
    buffer_load_dword v99, v6, s[12:15], s21 offen
    v_subrev_u32 v5, 4, v4
    v_cmp_gt_i32 vcc, 0, v5
    v_cvt_f32_u32 v8, v5
    v_cvt_pk_bf16_f32 v8, v8, v8
    v_lshlrev_b32 v8, 16, v8
    v_cvt_u32_f32 v6, v8
    v_lshrrev_b32 v8, 23, v8
    v_subrev_u32 v8, 134, v8
    v_max_i32 v8, 0, v8
    v_lshrrev_b32 v6, v8, v6
    v_lshl_add_u32 v6, v8, 7, v6
    v_lshlrev_b32 v6, 2, v6
    buffer_load_dword v100, v6, s[12:15], s21 offen
    v_subrev_u32 v5, 5, v4
    v_cmp_gt_i32 vcc, 0, v5
    v_cvt_f32_u32 v8, v5
    v_cvt_pk_bf16_f32 v8, v8, v8
    v_lshlrev_b32 v8, 16, v8
    v_cvt_u32_f32 v6, v8
    v_lshrrev_b32 v8, 23, v8
    v_subrev_u32 v8, 134, v8
    v_max_i32 v8, 0, v8
    v_lshrrev_b32 v6, v8, v6
    v_lshl_add_u32 v6, v8, 7, v6
    v_lshlrev_b32 v6, 2, v6
    buffer_load_dword v101, v6, s[12:15], s21 offen
    v_subrev_u32 v5, 6, v4
    v_cmp_gt_i32 vcc, 0, v5
    v_cvt_f32_u32 v8, v5
    v_cvt_pk_bf16_f32 v8, v8, v8
    v_lshlrev_b32 v8, 16, v8
    v_cvt_u32_f32 v6, v8
    v_lshrrev_b32 v8, 23, v8
    v_subrev_u32 v8, 134, v8
    v_max_i32 v8, 0, v8
    v_lshrrev_b32 v6, v8, v6
    v_lshl_add_u32 v6, v8, 7, v6
    v_lshlrev_b32 v6, 2, v6
    buffer_load_dword v102, v6, s[12:15], s21 offen
    v_subrev_u32 v5, 7, v4
    v_cmp_gt_i32 vcc, 0, v5
    v_cvt_f32_u32 v8, v5
    v_cvt_pk_bf16_f32 v8, v8, v8
    v_lshlrev_b32 v8, 16, v8
    v_cvt_u32_f32 v6, v8
    v_lshrrev_b32 v8, 23, v8
    v_subrev_u32 v8, 134, v8
    v_max_i32 v8, 0, v8
    v_lshrrev_b32 v6, v8, v6
    v_lshl_add_u32 v6, v8, 7, v6
    v_lshlrev_b32 v6, 2, v6
    buffer_load_dword v103, v6, s[12:15], s21 offen
    v_subrev_u32 v5, 8, v4
    v_cmp_gt_i32 vcc, 0, v5
    v_cvt_f32_u32 v8, v5
    v_cvt_pk_bf16_f32 v8, v8, v8
    v_lshlrev_b32 v8, 16, v8
    v_cvt_u32_f32 v6, v8
    v_lshrrev_b32 v8, 23, v8
    v_subrev_u32 v8, 134, v8
    v_max_i32 v8, 0, v8
    v_lshrrev_b32 v6, v8, v6
    v_lshl_add_u32 v6, v8, 7, v6
    v_lshlrev_b32 v6, 2, v6
    v_cndmask_b32 v6, v6, v7, vcc
    buffer_load_dword v104, v6, s[12:15], s21 offen
    v_subrev_u32 v5, 9, v4
    v_cmp_gt_i32 vcc, 0, v5
    v_cvt_f32_u32 v8, v5
    v_cvt_pk_bf16_f32 v8, v8, v8
    v_lshlrev_b32 v8, 16, v8
    v_cvt_u32_f32 v6, v8
    v_lshrrev_b32 v8, 23, v8
    v_subrev_u32 v8, 134, v8
    v_max_i32 v8, 0, v8
    v_lshrrev_b32 v6, v8, v6
    v_lshl_add_u32 v6, v8, 7, v6
    v_lshlrev_b32 v6, 2, v6
    v_cndmask_b32 v6, v6, v7, vcc
    buffer_load_dword v105, v6, s[12:15], s21 offen
    v_subrev_u32 v5, 10, v4
    v_cmp_gt_i32 vcc, 0, v5
    v_cvt_f32_u32 v8, v5
    v_cvt_pk_bf16_f32 v8, v8, v8
    v_lshlrev_b32 v8, 16, v8
    v_cvt_u32_f32 v6, v8
    v_lshrrev_b32 v8, 23, v8
    v_subrev_u32 v8, 134, v8
    v_max_i32 v8, 0, v8
    v_lshrrev_b32 v6, v8, v6
    v_lshl_add_u32 v6, v8, 7, v6
    v_lshlrev_b32 v6, 2, v6
    v_cndmask_b32 v6, v6, v7, vcc
    buffer_load_dword v106, v6, s[12:15], s21 offen
    v_subrev_u32 v5, 11, v4
    v_cmp_gt_i32 vcc, 0, v5
    v_cvt_f32_u32 v8, v5
    v_cvt_pk_bf16_f32 v8, v8, v8
    v_lshlrev_b32 v8, 16, v8
    v_cvt_u32_f32 v6, v8
    v_lshrrev_b32 v8, 23, v8
    v_subrev_u32 v8, 134, v8
    v_max_i32 v8, 0, v8
    v_lshrrev_b32 v6, v8, v6
    v_lshl_add_u32 v6, v8, 7, v6
    v_lshlrev_b32 v6, 2, v6
    v_cndmask_b32 v6, v6, v7, vcc
    buffer_load_dword v107, v6, s[12:15], s21 offen
    v_subrev_u32 v5, 12, v4
    v_cmp_gt_i32 vcc, 0, v5
    v_cvt_f32_u32 v8, v5
    v_cvt_pk_bf16_f32 v8, v8, v8
    v_lshlrev_b32 v8, 16, v8
    v_cvt_u32_f32 v6, v8
    v_lshrrev_b32 v8, 23, v8
    v_subrev_u32 v8, 134, v8
    v_max_i32 v8, 0, v8
    v_lshrrev_b32 v6, v8, v6
    v_lshl_add_u32 v6, v8, 7, v6
    v_lshlrev_b32 v6, 2, v6
    v_cndmask_b32 v6, v6, v7, vcc
    buffer_load_dword v108, v6, s[12:15], s21 offen
    v_subrev_u32 v5, 13, v4
    v_cmp_gt_i32 vcc, 0, v5
    v_cvt_f32_u32 v8, v5
    v_cvt_pk_bf16_f32 v8, v8, v8
    v_lshlrev_b32 v8, 16, v8
    v_cvt_u32_f32 v6, v8
    v_lshrrev_b32 v8, 23, v8
    v_subrev_u32 v8, 134, v8
    v_max_i32 v8, 0, v8
    v_lshrrev_b32 v6, v8, v6
    v_lshl_add_u32 v6, v8, 7, v6
    v_lshlrev_b32 v6, 2, v6
    v_cndmask_b32 v6, v6, v7, vcc
    buffer_load_dword v109, v6, s[12:15], s21 offen
    v_subrev_u32 v5, 14, v4
    v_cmp_gt_i32 vcc, 0, v5
    v_cvt_f32_u32 v8, v5
    v_cvt_pk_bf16_f32 v8, v8, v8
    v_lshlrev_b32 v8, 16, v8
    v_cvt_u32_f32 v6, v8
    v_lshrrev_b32 v8, 23, v8
    v_subrev_u32 v8, 134, v8
    v_max_i32 v8, 0, v8
    v_lshrrev_b32 v6, v8, v6
    v_lshl_add_u32 v6, v8, 7, v6
    v_lshlrev_b32 v6, 2, v6
    v_cndmask_b32 v6, v6, v7, vcc
    buffer_load_dword v110, v6, s[12:15], s21 offen
    v_subrev_u32 v5, 15, v4
    v_cmp_gt_i32 vcc, 0, v5
    v_cvt_f32_u32 v8, v5
    v_cvt_pk_bf16_f32 v8, v8, v8
    v_lshlrev_b32 v8, 16, v8
    v_cvt_u32_f32 v6, v8
    v_lshrrev_b32 v8, 23, v8
    v_subrev_u32 v8, 134, v8
    v_max_i32 v8, 0, v8
    v_lshrrev_b32 v6, v8, v6
    v_lshl_add_u32 v6, v8, 7, v6
    v_lshlrev_b32 v6, 2, v6
    v_cndmask_b32 v6, v6, v7, vcc
    buffer_load_dword v111, v6, s[12:15], s21 offen
    v_mov_b32 v20, 0
    v_mov_b32 v21, 0
    v_mov_b32 v22, 0
    v_mov_b32 v23, 0
    v_add_u32 v36, 33280, v3
    v_cmp_gt_u32 vcc, 160, v0
    s_and_saveexec_b64 s[24:25], vcc
    ds_write_b128 v3, v[20:23]
    s_mov_b64 exec, s[24:25]
    v_cmp_gt_u32 vcc, 4, v0
    s_and_saveexec_b64 s[24:25], vcc
    ds_write_b128 v3, v[20:23] offset:11776
    ds_write_b128 v3, v[20:23] offset:15936
    ds_write_b128 v3, v[20:23] offset:20096
    ds_write_b128 v3, v[20:23] offset:24256
    ds_write_b128 v3, v[20:23] offset:28416
    ds_write_b128 v3, v[20:23] offset:32576
    ds_write_b128 v3, v[20:23] offset:36736
    ds_write_b128 v3, v[20:23] offset:40896
    ds_write_b128 v36, v[20:23] offset:11776
    ds_write_b128 v36, v[20:23] offset:15936
    ds_write_b128 v36, v[20:23] offset:20096
    ds_write_b128 v36, v[20:23] offset:24256
    ds_write_b128 v36, v[20:23] offset:28416
    ds_write_b128 v36, v[20:23] offset:32576
    ds_write_b128 v36, v[20:23] offset:36736
    ds_write_b128 v36, v[20:23] offset:40896
    s_mov_b64 exec, s[24:25]
    v_lshrrev_b32 v5, 2, v0
    v_and_b32 v6, 3, v0
    v_mul_u32_u24 v5, 80, v5
    v_lshl_add_u32 v5, v6, 4, v5
    s_waitcnt vmcnt(16)
    ds_write_b128 v5, v[40:43] offset:2560
    s_waitcnt vmcnt(0)
    v_cvt_pk_bf16_f32 v8, v96, v97
    v_lshlrev_b32 v32, 16, v8
    v_and_b32 v33, 0xffff0000, v8
    v_sub_f32 v32, v96, v32
    v_sub_f32 v33, v97, v33
    v_cvt_pk_bf16_f32 v24, v32, v33
    v_cvt_pk_bf16_f32 v9, v98, v99
    v_lshlrev_b32 v32, 16, v9
    v_and_b32 v33, 0xffff0000, v9
    v_sub_f32 v32, v98, v32
    v_sub_f32 v33, v99, v33
    v_cvt_pk_bf16_f32 v25, v32, v33
    v_cvt_pk_bf16_f32 v10, v100, v101
    v_lshlrev_b32 v32, 16, v10
    v_and_b32 v33, 0xffff0000, v10
    v_sub_f32 v32, v100, v32
    v_sub_f32 v33, v101, v33
    v_cvt_pk_bf16_f32 v26, v32, v33
    v_cvt_pk_bf16_f32 v11, v102, v103
    v_lshlrev_b32 v32, 16, v11
    v_and_b32 v33, 0xffff0000, v11
    v_sub_f32 v32, v102, v32
    v_sub_f32 v33, v103, v33
    v_cvt_pk_bf16_f32 v27, v32, v33
    v_cvt_pk_bf16_f32 v12, v104, v105
    v_lshlrev_b32 v32, 16, v12
    v_and_b32 v33, 0xffff0000, v12
    v_sub_f32 v32, v104, v32
    v_sub_f32 v33, v105, v33
    v_cvt_pk_bf16_f32 v28, v32, v33
    v_cvt_pk_bf16_f32 v13, v106, v107
    v_lshlrev_b32 v32, 16, v13
    v_and_b32 v33, 0xffff0000, v13
    v_sub_f32 v32, v106, v32
    v_sub_f32 v33, v107, v33
    v_cvt_pk_bf16_f32 v29, v32, v33
    v_cvt_pk_bf16_f32 v14, v108, v109
    v_lshlrev_b32 v32, 16, v14
    v_and_b32 v33, 0xffff0000, v14
    v_sub_f32 v32, v108, v32
    v_sub_f32 v33, v109, v33
    v_cvt_pk_bf16_f32 v30, v32, v33
    v_cvt_pk_bf16_f32 v15, v110, v111
    v_lshlrev_b32 v32, 16, v15
    v_and_b32 v33, 0xffff0000, v15
    v_sub_f32 v32, v110, v32
    v_sub_f32 v33, v111, v33
    v_cvt_pk_bf16_f32 v31, v32, v33
    ds_write_b128 v3, v[8:11] offset:7680
    v_alignbit_b32 v48, v9, v8, 16
    v_alignbit_b32 v49, v10, v9, 16
    v_alignbit_b32 v50, v11, v10, 16
    v_alignbit_b32 v51, v12, v11, 16
    ds_write_b128 v3, v[48:51] offset:11840
    v_mov_b32 v52, v9
    v_mov_b32 v53, v10
    v_mov_b32 v54, v11
    v_mov_b32 v55, v12
    ds_write_b128 v3, v[52:55] offset:16000
    v_alignbit_b32 v56, v10, v9, 16
    v_alignbit_b32 v57, v11, v10, 16
    v_alignbit_b32 v58, v12, v11, 16
    v_alignbit_b32 v59, v13, v12, 16
    ds_write_b128 v3, v[56:59] offset:20160
    ds_write_b128 v3, v[10:13] offset:24320
    v_alignbit_b32 v48, v11, v10, 16
    v_alignbit_b32 v49, v12, v11, 16
    v_alignbit_b32 v50, v13, v12, 16
    v_alignbit_b32 v51, v14, v13, 16
    ds_write_b128 v3, v[48:51] offset:28480
    v_mov_b32 v52, v11
    v_mov_b32 v53, v12
    v_mov_b32 v54, v13
    v_mov_b32 v55, v14
    ds_write_b128 v3, v[52:55] offset:32640
    v_alignbit_b32 v56, v12, v11, 16
    v_alignbit_b32 v57, v13, v12, 16
    v_alignbit_b32 v58, v14, v13, 16
    v_alignbit_b32 v59, v15, v14, 16
    ds_write_b128 v3, v[56:59] offset:36800
    ds_write_b128 v36, v[24:27] offset:7680
    v_alignbit_b32 v48, v25, v24, 16
    v_alignbit_b32 v49, v26, v25, 16
    v_alignbit_b32 v50, v27, v26, 16
    v_alignbit_b32 v51, v28, v27, 16
    ds_write_b128 v36, v[48:51] offset:11840
    v_mov_b32 v52, v25
    v_mov_b32 v53, v26
    v_mov_b32 v54, v27
    v_mov_b32 v55, v28
    ds_write_b128 v36, v[52:55] offset:16000
    v_alignbit_b32 v56, v26, v25, 16
    v_alignbit_b32 v57, v27, v26, 16
    v_alignbit_b32 v58, v28, v27, 16
    v_alignbit_b32 v59, v29, v28, 16
    ds_write_b128 v36, v[56:59] offset:20160
    ds_write_b128 v36, v[26:29] offset:24320
    v_alignbit_b32 v48, v27, v26, 16
    v_alignbit_b32 v49, v28, v27, 16
    v_alignbit_b32 v50, v29, v28, 16
    v_alignbit_b32 v51, v30, v29, 16
    ds_write_b128 v36, v[48:51] offset:28480
    v_mov_b32 v52, v27
    v_mov_b32 v53, v28
    v_mov_b32 v54, v29
    v_mov_b32 v55, v30
    ds_write_b128 v36, v[52:55] offset:32640
    v_alignbit_b32 v56, v28, v27, 16
    v_alignbit_b32 v57, v29, v28, 16
    v_alignbit_b32 v58, v30, v29, 16
    v_alignbit_b32 v59, v31, v30, 16
    ds_write_b128 v36, v[56:59] offset:36800
    s_waitcnt lgkmcnt(0)
    s_barrier
    s_and_b32 s23, s22, 1
    s_lshr_b32 s24, s22, 1
    v_and_b32 v4, 31, v1
    v_lshrrev_b32 v5, 5, v1
    v_sub_u32 v6, 7, v4
    v_and_b32 v6, 7, v6
    v_sub_u32 v7, 31, v4
    v_lshl_add_u32 v7, v5, 3, v7
    s_lshl_b32 s25, s23, 4
    v_add_u32 v7, s25, v7
    v_sub_u32 v7, v7, v6
    v_lshlrev_b32 v7, 1, v7
    v_mul_u32_u24 v8, 4160, v6
    v_add_u32 v7, v7, v8
    s_mul_i32 s25, s24, 33280
    s_add_u32 s25, s25, 7680
    v_add_u32 v7, s25, v7
    v_add_u32 v8, 1, v4
    v_mul_u32_u24 v8, 80, v8
    v_lshl_add_u32 v8, v5, 4, v8
    s_lshl_b32 s25, s23, 5
    v_add_u32 v8, s25, v8
    v_mov_b32 v64, 0
    v_mov_b32 v65, 0
    v_mov_b32 v66, 0
    v_mov_b32 v67, 0
    v_mov_b32 v68, 0
    v_mov_b32 v69, 0
    v_mov_b32 v70, 0
    v_mov_b32 v71, 0
    v_mov_b32 v72, 0
    v_mov_b32 v73, 0
    v_mov_b32 v74, 0
    v_mov_b32 v75, 0
    v_mov_b32 v76, 0
    v_mov_b32 v77, 0
    v_mov_b32 v78, 0
    v_mov_b32 v79, 0
    v_mov_b32 v80, 0
    v_mov_b32 v81, 0
    v_mov_b32 v82, 0
    v_mov_b32 v83, 0
    v_mov_b32 v84, 0
    v_mov_b32 v85, 0
    v_mov_b32 v86, 0
    v_mov_b32 v87, 0
    v_mov_b32 v88, 0
    v_mov_b32 v89, 0
    v_mov_b32 v90, 0
    v_mov_b32 v91, 0
    v_mov_b32 v92, 0
    v_mov_b32 v93, 0
    v_mov_b32 v94, 0
    v_mov_b32 v95, 0
    ds_read_b128 v[16:19], v7 offset:4032
    ds_read_b128 v[20:23], v8 offset:5040
    ds_read_b128 v[24:27], v8 offset:2480
    ds_read_b128 v[28:31], v7 offset:3968
    ds_read_b128 v[32:35], v8 offset:4960
    ds_read_b128 v[36:39], v8 offset:2400
    s_waitcnt lgkmcnt(3)
    v_mfma_f32_32x32x16_bf16 v[80:95], v[20:23], v[16:19], v[80:95]
    v_mfma_f32_32x32x16_bf16 v[64:79], v[24:27], v[16:19], v[64:79]
    ds_read_b128 v[16:19], v7 offset:3904
    ds_read_b128 v[20:23], v8 offset:4880
    ds_read_b128 v[24:27], v8 offset:2320
    s_waitcnt lgkmcnt(3)
    v_mfma_f32_32x32x16_bf16 v[80:95], v[32:35], v[28:31], v[80:95]
    v_mfma_f32_32x32x16_bf16 v[64:79], v[36:39], v[28:31], v[64:79]
    ds_read_b128 v[28:31], v7 offset:3840
    ds_read_b128 v[32:35], v8 offset:4800
    ds_read_b128 v[36:39], v8 offset:2240
    s_waitcnt lgkmcnt(3)
    v_mfma_f32_32x32x16_bf16 v[80:95], v[20:23], v[16:19], v[80:95]
    v_mfma_f32_32x32x16_bf16 v[64:79], v[24:27], v[16:19], v[64:79]
    ds_read_b128 v[16:19], v7 offset:3776
    ds_read_b128 v[20:23], v8 offset:4720
    ds_read_b128 v[24:27], v8 offset:2160
    s_waitcnt lgkmcnt(3)
    v_mfma_f32_32x32x16_bf16 v[80:95], v[32:35], v[28:31], v[80:95]
    v_mfma_f32_32x32x16_bf16 v[64:79], v[36:39], v[28:31], v[64:79]
    ds_read_b128 v[28:31], v7 offset:3712
    ds_read_b128 v[32:35], v8 offset:4640
    ds_read_b128 v[36:39], v8 offset:2080
    s_waitcnt lgkmcnt(3)
    v_mfma_f32_32x32x16_bf16 v[80:95], v[20:23], v[16:19], v[80:95]
    v_mfma_f32_32x32x16_bf16 v[64:79], v[24:27], v[16:19], v[64:79]
    ds_read_b128 v[16:19], v7 offset:3648
    ds_read_b128 v[20:23], v8 offset:4560
    ds_read_b128 v[24:27], v8 offset:2000
    s_waitcnt lgkmcnt(3)
    v_mfma_f32_32x32x16_bf16 v[80:95], v[32:35], v[28:31], v[80:95]
    v_mfma_f32_32x32x16_bf16 v[64:79], v[36:39], v[28:31], v[64:79]
    ds_read_b128 v[28:31], v7 offset:3584
    ds_read_b128 v[32:35], v8 offset:4480
    ds_read_b128 v[36:39], v8 offset:1920
    s_waitcnt lgkmcnt(3)
    v_mfma_f32_32x32x16_bf16 v[80:95], v[20:23], v[16:19], v[80:95]
    v_mfma_f32_32x32x16_bf16 v[64:79], v[24:27], v[16:19], v[64:79]
    ds_read_b128 v[16:19], v7 offset:3520
    ds_read_b128 v[20:23], v8 offset:4400
    ds_read_b128 v[24:27], v8 offset:1840
    s_waitcnt lgkmcnt(3)
    v_mfma_f32_32x32x16_bf16 v[80:95], v[32:35], v[28:31], v[80:95]
    v_mfma_f32_32x32x16_bf16 v[64:79], v[36:39], v[28:31], v[64:79]
    ds_read_b128 v[28:31], v7 offset:3456
    ds_read_b128 v[32:35], v8 offset:4320
    ds_read_b128 v[36:39], v8 offset:1760
    s_waitcnt lgkmcnt(3)
    v_mfma_f32_32x32x16_bf16 v[80:95], v[20:23], v[16:19], v[80:95]
    v_mfma_f32_32x32x16_bf16 v[64:79], v[24:27], v[16:19], v[64:79]
    ds_read_b128 v[16:19], v7 offset:3392
    ds_read_b128 v[20:23], v8 offset:4240
    ds_read_b128 v[24:27], v8 offset:1680
    s_waitcnt lgkmcnt(3)
    v_mfma_f32_32x32x16_bf16 v[80:95], v[32:35], v[28:31], v[80:95]
    v_mfma_f32_32x32x16_bf16 v[64:79], v[36:39], v[28:31], v[64:79]
    ds_read_b128 v[28:31], v7 offset:3328
    ds_read_b128 v[32:35], v8 offset:4160
    ds_read_b128 v[36:39], v8 offset:1600
    s_waitcnt lgkmcnt(3)
    v_mfma_f32_32x32x16_bf16 v[80:95], v[20:23], v[16:19], v[80:95]
    v_mfma_f32_32x32x16_bf16 v[64:79], v[24:27], v[16:19], v[64:79]
    ds_read_b128 v[16:19], v7 offset:3264
    ds_read_b128 v[20:23], v8 offset:4080
    ds_read_b128 v[24:27], v8 offset:1520
    s_waitcnt lgkmcnt(3)
    v_mfma_f32_32x32x16_bf16 v[80:95], v[32:35], v[28:31], v[80:95]
    v_mfma_f32_32x32x16_bf16 v[64:79], v[36:39], v[28:31], v[64:79]
    ds_read_b128 v[28:31], v7 offset:3200
    ds_read_b128 v[32:35], v8 offset:4000
    ds_read_b128 v[36:39], v8 offset:1440
    s_waitcnt lgkmcnt(3)
    v_mfma_f32_32x32x16_bf16 v[80:95], v[20:23], v[16:19], v[80:95]
    v_mfma_f32_32x32x16_bf16 v[64:79], v[24:27], v[16:19], v[64:79]
    ds_read_b128 v[16:19], v7 offset:3136
    ds_read_b128 v[20:23], v8 offset:3920
    ds_read_b128 v[24:27], v8 offset:1360
    s_waitcnt lgkmcnt(3)
    v_mfma_f32_32x32x16_bf16 v[80:95], v[32:35], v[28:31], v[80:95]
    v_mfma_f32_32x32x16_bf16 v[64:79], v[36:39], v[28:31], v[64:79]
    ds_read_b128 v[28:31], v7 offset:3072
    ds_read_b128 v[32:35], v8 offset:3840
    ds_read_b128 v[36:39], v8 offset:1280
    s_waitcnt lgkmcnt(3)
    v_mfma_f32_32x32x16_bf16 v[80:95], v[20:23], v[16:19], v[80:95]
    v_mfma_f32_32x32x16_bf16 v[64:79], v[24:27], v[16:19], v[64:79]
    ds_read_b128 v[16:19], v7 offset:3008
    ds_read_b128 v[20:23], v8 offset:3760
    ds_read_b128 v[24:27], v8 offset:1200
    s_waitcnt lgkmcnt(3)
    v_mfma_f32_32x32x16_bf16 v[80:95], v[32:35], v[28:31], v[80:95]
    v_mfma_f32_32x32x16_bf16 v[64:79], v[36:39], v[28:31], v[64:79]
    ds_read_b128 v[28:31], v7 offset:2944
    ds_read_b128 v[32:35], v8 offset:3680
    ds_read_b128 v[36:39], v8 offset:1120
    s_waitcnt lgkmcnt(3)
    v_mfma_f32_32x32x16_bf16 v[80:95], v[20:23], v[16:19], v[80:95]
    v_mfma_f32_32x32x16_bf16 v[64:79], v[24:27], v[16:19], v[64:79]
    ds_read_b128 v[16:19], v7 offset:2880
    ds_read_b128 v[20:23], v8 offset:3600
    ds_read_b128 v[24:27], v8 offset:1040
    s_waitcnt lgkmcnt(3)
    v_mfma_f32_32x32x16_bf16 v[80:95], v[32:35], v[28:31], v[80:95]
    v_mfma_f32_32x32x16_bf16 v[64:79], v[36:39], v[28:31], v[64:79]
    ds_read_b128 v[28:31], v7 offset:2816
    ds_read_b128 v[32:35], v8 offset:3520
    ds_read_b128 v[36:39], v8 offset:960
    s_waitcnt lgkmcnt(3)
    v_mfma_f32_32x32x16_bf16 v[80:95], v[20:23], v[16:19], v[80:95]
    v_mfma_f32_32x32x16_bf16 v[64:79], v[24:27], v[16:19], v[64:79]
    ds_read_b128 v[16:19], v7 offset:2752
    ds_read_b128 v[20:23], v8 offset:3440
    ds_read_b128 v[24:27], v8 offset:880
    s_waitcnt lgkmcnt(3)
    v_mfma_f32_32x32x16_bf16 v[80:95], v[32:35], v[28:31], v[80:95]
    v_mfma_f32_32x32x16_bf16 v[64:79], v[36:39], v[28:31], v[64:79]
    ds_read_b128 v[28:31], v7 offset:2688
    ds_read_b128 v[32:35], v8 offset:3360
    ds_read_b128 v[36:39], v8 offset:800
    s_waitcnt lgkmcnt(3)
    v_mfma_f32_32x32x16_bf16 v[80:95], v[20:23], v[16:19], v[80:95]
    v_mfma_f32_32x32x16_bf16 v[64:79], v[24:27], v[16:19], v[64:79]
    ds_read_b128 v[16:19], v7 offset:2624
    ds_read_b128 v[20:23], v8 offset:3280
    ds_read_b128 v[24:27], v8 offset:720
    s_waitcnt lgkmcnt(3)
    v_mfma_f32_32x32x16_bf16 v[80:95], v[32:35], v[28:31], v[80:95]
    v_mfma_f32_32x32x16_bf16 v[64:79], v[36:39], v[28:31], v[64:79]
    ds_read_b128 v[28:31], v7 offset:2560
    ds_read_b128 v[32:35], v8 offset:3200
    ds_read_b128 v[36:39], v8 offset:640
    s_waitcnt lgkmcnt(3)
    v_mfma_f32_32x32x16_bf16 v[80:95], v[20:23], v[16:19], v[80:95]
    v_mfma_f32_32x32x16_bf16 v[64:79], v[24:27], v[16:19], v[64:79]
    ds_read_b128 v[16:19], v7 offset:2496
    ds_read_b128 v[20:23], v8 offset:3120
    ds_read_b128 v[24:27], v8 offset:560
    s_waitcnt lgkmcnt(3)
    v_mfma_f32_32x32x16_bf16 v[80:95], v[32:35], v[28:31], v[80:95]
    v_mfma_f32_32x32x16_bf16 v[64:79], v[36:39], v[28:31], v[64:79]
    ds_read_b128 v[28:31], v7 offset:2432
    ds_read_b128 v[32:35], v8 offset:3040
    ds_read_b128 v[36:39], v8 offset:480
    s_waitcnt lgkmcnt(3)
    v_mfma_f32_32x32x16_bf16 v[80:95], v[20:23], v[16:19], v[80:95]
    v_mfma_f32_32x32x16_bf16 v[64:79], v[24:27], v[16:19], v[64:79]
    ds_read_b128 v[16:19], v7 offset:2368
    ds_read_b128 v[20:23], v8 offset:2960
    ds_read_b128 v[24:27], v8 offset:400
    s_waitcnt lgkmcnt(3)
    v_mfma_f32_32x32x16_bf16 v[80:95], v[32:35], v[28:31], v[80:95]
    v_mfma_f32_32x32x16_bf16 v[64:79], v[36:39], v[28:31], v[64:79]
    ds_read_b128 v[28:31], v7 offset:2304
    ds_read_b128 v[32:35], v8 offset:2880
    ds_read_b128 v[36:39], v8 offset:320
    s_waitcnt lgkmcnt(3)
    v_mfma_f32_32x32x16_bf16 v[80:95], v[20:23], v[16:19], v[80:95]
    v_mfma_f32_32x32x16_bf16 v[64:79], v[24:27], v[16:19], v[64:79]
    ds_read_b128 v[16:19], v7 offset:2240
    ds_read_b128 v[20:23], v8 offset:2800
    ds_read_b128 v[24:27], v8 offset:240
    s_waitcnt lgkmcnt(3)
    v_mfma_f32_32x32x16_bf16 v[80:95], v[32:35], v[28:31], v[80:95]
    v_mfma_f32_32x32x16_bf16 v[64:79], v[36:39], v[28:31], v[64:79]
    ds_read_b128 v[28:31], v7 offset:2176
    ds_read_b128 v[32:35], v8 offset:2720
    ds_read_b128 v[36:39], v8 offset:160
    s_waitcnt lgkmcnt(3)
    v_mfma_f32_32x32x16_bf16 v[80:95], v[20:23], v[16:19], v[80:95]
    v_mfma_f32_32x32x16_bf16 v[64:79], v[24:27], v[16:19], v[64:79]
    ds_read_b128 v[16:19], v7 offset:2112
    ds_read_b128 v[20:23], v8 offset:2640
    ds_read_b128 v[24:27], v8 offset:80
    s_waitcnt lgkmcnt(3)
    v_mfma_f32_32x32x16_bf16 v[80:95], v[32:35], v[28:31], v[80:95]
    v_mfma_f32_32x32x16_bf16 v[64:79], v[36:39], v[28:31], v[64:79]
    ds_read_b128 v[28:31], v7 offset:2048
    ds_read_b128 v[32:35], v8 offset:2560
    ds_read_b128 v[36:39], v8 offset:0
    s_waitcnt lgkmcnt(3)
    v_mfma_f32_32x32x16_bf16 v[80:95], v[20:23], v[16:19], v[80:95]
    v_mfma_f32_32x32x16_bf16 v[64:79], v[24:27], v[16:19], v[64:79]
    ds_read_b128 v[16:19], v7 offset:1984
    ds_read_b128 v[20:23], v8 offset:2480
    s_waitcnt lgkmcnt(2)
    v_mfma_f32_32x32x16_bf16 v[80:95], v[32:35], v[28:31], v[80:95]
    v_mfma_f32_32x32x16_bf16 v[64:79], v[36:39], v[28:31], v[64:79]
    ds_read_b128 v[28:31], v7 offset:1920
    ds_read_b128 v[32:35], v8 offset:2400
    s_waitcnt lgkmcnt(2)
    v_mfma_f32_32x32x16_bf16 v[80:95], v[20:23], v[16:19], v[80:95]
    ds_read_b128 v[16:19], v7 offset:1856
    ds_read_b128 v[20:23], v8 offset:2320
    s_waitcnt lgkmcnt(2)
    v_mfma_f32_32x32x16_bf16 v[80:95], v[32:35], v[28:31], v[80:95]
    ds_read_b128 v[28:31], v7 offset:1792
    ds_read_b128 v[32:35], v8 offset:2240
    s_waitcnt lgkmcnt(2)
    v_mfma_f32_32x32x16_bf16 v[80:95], v[20:23], v[16:19], v[80:95]
    ds_read_b128 v[16:19], v7 offset:1728
    ds_read_b128 v[20:23], v8 offset:2160
    s_waitcnt lgkmcnt(2)
    v_mfma_f32_32x32x16_bf16 v[80:95], v[32:35], v[28:31], v[80:95]
    ds_read_b128 v[28:31], v7 offset:1664
    ds_read_b128 v[32:35], v8 offset:2080
    s_waitcnt lgkmcnt(2)
    v_mfma_f32_32x32x16_bf16 v[80:95], v[20:23], v[16:19], v[80:95]
    ds_read_b128 v[16:19], v7 offset:1600
    ds_read_b128 v[20:23], v8 offset:2000
    s_waitcnt lgkmcnt(2)
    v_mfma_f32_32x32x16_bf16 v[80:95], v[32:35], v[28:31], v[80:95]
    ds_read_b128 v[28:31], v7 offset:1536
    ds_read_b128 v[32:35], v8 offset:1920
    s_waitcnt lgkmcnt(2)
    v_mfma_f32_32x32x16_bf16 v[80:95], v[20:23], v[16:19], v[80:95]
    ds_read_b128 v[16:19], v7 offset:1472
    ds_read_b128 v[20:23], v8 offset:1840
    s_waitcnt lgkmcnt(2)
    v_mfma_f32_32x32x16_bf16 v[80:95], v[32:35], v[28:31], v[80:95]
    ds_read_b128 v[28:31], v7 offset:1408
    ds_read_b128 v[32:35], v8 offset:1760
    s_waitcnt lgkmcnt(2)
    v_mfma_f32_32x32x16_bf16 v[80:95], v[20:23], v[16:19], v[80:95]
    ds_read_b128 v[16:19], v7 offset:1344
    ds_read_b128 v[20:23], v8 offset:1680
    s_waitcnt lgkmcnt(2)
    v_mfma_f32_32x32x16_bf16 v[80:95], v[32:35], v[28:31], v[80:95]
    ds_read_b128 v[28:31], v7 offset:1280
    ds_read_b128 v[32:35], v8 offset:1600
    s_waitcnt lgkmcnt(2)
    v_mfma_f32_32x32x16_bf16 v[80:95], v[20:23], v[16:19], v[80:95]
    ds_read_b128 v[16:19], v7 offset:1216
    ds_read_b128 v[20:23], v8 offset:1520
    s_waitcnt lgkmcnt(2)
    v_mfma_f32_32x32x16_bf16 v[80:95], v[32:35], v[28:31], v[80:95]
    ds_read_b128 v[28:31], v7 offset:1152
    ds_read_b128 v[32:35], v8 offset:1440
    s_waitcnt lgkmcnt(2)
    v_mfma_f32_32x32x16_bf16 v[80:95], v[20:23], v[16:19], v[80:95]
    ds_read_b128 v[16:19], v7 offset:1088
    ds_read_b128 v[20:23], v8 offset:1360
    s_waitcnt lgkmcnt(2)
    v_mfma_f32_32x32x16_bf16 v[80:95], v[32:35], v[28:31], v[80:95]
    ds_read_b128 v[28:31], v7 offset:1024
    ds_read_b128 v[32:35], v8 offset:1280
    s_waitcnt lgkmcnt(2)
    v_mfma_f32_32x32x16_bf16 v[80:95], v[20:23], v[16:19], v[80:95]
    ds_read_b128 v[16:19], v7 offset:960
    ds_read_b128 v[20:23], v8 offset:1200
    s_waitcnt lgkmcnt(2)
    v_mfma_f32_32x32x16_bf16 v[80:95], v[32:35], v[28:31], v[80:95]
    ds_read_b128 v[28:31], v7 offset:896
    ds_read_b128 v[32:35], v8 offset:1120
    s_waitcnt lgkmcnt(2)
    v_mfma_f32_32x32x16_bf16 v[80:95], v[20:23], v[16:19], v[80:95]
    ds_read_b128 v[16:19], v7 offset:832
    ds_read_b128 v[20:23], v8 offset:1040
    s_waitcnt lgkmcnt(2)
    v_mfma_f32_32x32x16_bf16 v[80:95], v[32:35], v[28:31], v[80:95]
    ds_read_b128 v[28:31], v7 offset:768
    ds_read_b128 v[32:35], v8 offset:960
    s_waitcnt lgkmcnt(2)
    v_mfma_f32_32x32x16_bf16 v[80:95], v[20:23], v[16:19], v[80:95]
    ds_read_b128 v[16:19], v7 offset:704
    ds_read_b128 v[20:23], v8 offset:880
    s_waitcnt lgkmcnt(2)
    v_mfma_f32_32x32x16_bf16 v[80:95], v[32:35], v[28:31], v[80:95]
    ds_read_b128 v[28:31], v7 offset:640
    ds_read_b128 v[32:35], v8 offset:800
    s_waitcnt lgkmcnt(2)
    v_mfma_f32_32x32x16_bf16 v[80:95], v[20:23], v[16:19], v[80:95]
    ds_read_b128 v[16:19], v7 offset:576
    ds_read_b128 v[20:23], v8 offset:720
    s_waitcnt lgkmcnt(2)
    v_mfma_f32_32x32x16_bf16 v[80:95], v[32:35], v[28:31], v[80:95]
    ds_read_b128 v[28:31], v7 offset:512
    ds_read_b128 v[32:35], v8 offset:640
    s_waitcnt lgkmcnt(2)
    v_mfma_f32_32x32x16_bf16 v[80:95], v[20:23], v[16:19], v[80:95]
    ds_read_b128 v[16:19], v7 offset:448
    ds_read_b128 v[20:23], v8 offset:560
    s_waitcnt lgkmcnt(2)
    v_mfma_f32_32x32x16_bf16 v[80:95], v[32:35], v[28:31], v[80:95]
    ds_read_b128 v[28:31], v7 offset:384
    ds_read_b128 v[32:35], v8 offset:480
    s_waitcnt lgkmcnt(2)
    v_mfma_f32_32x32x16_bf16 v[80:95], v[20:23], v[16:19], v[80:95]
    ds_read_b128 v[16:19], v7 offset:320
    ds_read_b128 v[20:23], v8 offset:400
    s_waitcnt lgkmcnt(2)
    v_mfma_f32_32x32x16_bf16 v[80:95], v[32:35], v[28:31], v[80:95]
    ds_read_b128 v[28:31], v7 offset:256
    ds_read_b128 v[32:35], v8 offset:320
    s_waitcnt lgkmcnt(2)
    v_mfma_f32_32x32x16_bf16 v[80:95], v[20:23], v[16:19], v[80:95]
    ds_read_b128 v[16:19], v7 offset:192
    ds_read_b128 v[20:23], v8 offset:240
    s_waitcnt lgkmcnt(2)
    v_mfma_f32_32x32x16_bf16 v[80:95], v[32:35], v[28:31], v[80:95]
    ds_read_b128 v[28:31], v7 offset:128
    ds_read_b128 v[32:35], v8 offset:160
    s_waitcnt lgkmcnt(2)
    v_mfma_f32_32x32x16_bf16 v[80:95], v[20:23], v[16:19], v[80:95]
    ds_read_b128 v[16:19], v7 offset:64
    ds_read_b128 v[20:23], v8 offset:80
    s_waitcnt lgkmcnt(2)
    v_mfma_f32_32x32x16_bf16 v[80:95], v[32:35], v[28:31], v[80:95]
    ds_read_b128 v[28:31], v7 offset:0
    ds_read_b128 v[32:35], v8 offset:0
    s_waitcnt lgkmcnt(2)
    v_mfma_f32_32x32x16_bf16 v[80:95], v[20:23], v[16:19], v[80:95]
    s_waitcnt lgkmcnt(0)
    v_mfma_f32_32x32x16_bf16 v[80:95], v[32:35], v[28:31], v[80:95]
    s_nop 15
    s_nop 15
    s_barrier
    s_lshl_b32 s25, s22, 13
    v_lshlrev_b32 v9, 2, v1
    v_add_u32 v10, s25, v9
    ds_write_b32 v10, v64 offset:0
    ds_write_b32 v10, v65 offset:256
    ds_write_b32 v10, v66 offset:512
    ds_write_b32 v10, v67 offset:768
    ds_write_b32 v10, v68 offset:1024
    ds_write_b32 v10, v69 offset:1280
    ds_write_b32 v10, v70 offset:1536
    ds_write_b32 v10, v71 offset:1792
    ds_write_b32 v10, v72 offset:2048
    ds_write_b32 v10, v73 offset:2304
    ds_write_b32 v10, v74 offset:2560
    ds_write_b32 v10, v75 offset:2816
    ds_write_b32 v10, v76 offset:3072
    ds_write_b32 v10, v77 offset:3328
    ds_write_b32 v10, v78 offset:3584
    ds_write_b32 v10, v79 offset:3840
    ds_write_b32 v10, v80 offset:4096
    ds_write_b32 v10, v81 offset:4352
    ds_write_b32 v10, v82 offset:4608
    ds_write_b32 v10, v83 offset:4864
    ds_write_b32 v10, v84 offset:5120
    ds_write_b32 v10, v85 offset:5376
    ds_write_b32 v10, v86 offset:5632
    ds_write_b32 v10, v87 offset:5888
    ds_write_b32 v10, v88 offset:6144
    ds_write_b32 v10, v89 offset:6400
    ds_write_b32 v10, v90 offset:6656
    ds_write_b32 v10, v91 offset:6912
    ds_write_b32 v10, v92 offset:7168
    ds_write_b32 v10, v93 offset:7424
    ds_write_b32 v10, v94 offset:7680
    ds_write_b32 v10, v95 offset:7936
    s_waitcnt lgkmcnt(0)
    s_barrier
    s_lshl_b32 s25, s22, 11
    v_add_u32 v10, s25, v9
    ds_read_b32 v16, v10 offset:0
    ds_read_b32 v17, v10 offset:256
    ds_read_b32 v18, v10 offset:512
    ds_read_b32 v19, v10 offset:768
    ds_read_b32 v20, v10 offset:1024
    ds_read_b32 v21, v10 offset:1280
    ds_read_b32 v22, v10 offset:1536
    ds_read_b32 v23, v10 offset:1792
    ds_read_b32 v24, v10 offset:8192
    ds_read_b32 v25, v10 offset:8448
    ds_read_b32 v26, v10 offset:8704
    ds_read_b32 v27, v10 offset:8960
    ds_read_b32 v28, v10 offset:9216
    ds_read_b32 v29, v10 offset:9472
    ds_read_b32 v30, v10 offset:9728
    ds_read_b32 v31, v10 offset:9984
    ds_read_b32 v32, v10 offset:16384
    ds_read_b32 v33, v10 offset:16640
    ds_read_b32 v34, v10 offset:16896
    ds_read_b32 v35, v10 offset:17152
    ds_read_b32 v36, v10 offset:17408
    ds_read_b32 v37, v10 offset:17664
    ds_read_b32 v38, v10 offset:17920
    ds_read_b32 v39, v10 offset:18176
    ds_read_b32 v40, v10 offset:24576
    ds_read_b32 v41, v10 offset:24832
    ds_read_b32 v42, v10 offset:25088
    ds_read_b32 v43, v10 offset:25344
    ds_read_b32 v44, v10 offset:25600
    ds_read_b32 v45, v10 offset:25856
    ds_read_b32 v46, v10 offset:26112
    ds_read_b32 v47, v10 offset:26368
    s_waitcnt lgkmcnt(0)
    v_add_f32 v16, v16, v24
    v_add_f32 v32, v32, v40
    v_add_f32 v16, v16, v32
    v_cvt_pk_bf16_f32 v16, v16, v16
    v_add_f32 v17, v17, v25
    v_add_f32 v33, v33, v41
    v_add_f32 v17, v17, v33
    v_cvt_pk_bf16_f32 v17, v17, v17
    v_add_f32 v18, v18, v26
    v_add_f32 v34, v34, v42
    v_add_f32 v18, v18, v34
    v_cvt_pk_bf16_f32 v18, v18, v18
    v_add_f32 v19, v19, v27
    v_add_f32 v35, v35, v43
    v_add_f32 v19, v19, v35
    v_cvt_pk_bf16_f32 v19, v19, v19
    v_add_f32 v20, v20, v28
    v_add_f32 v36, v36, v44
    v_add_f32 v20, v20, v36
    v_cvt_pk_bf16_f32 v20, v20, v20
    v_add_f32 v21, v21, v29
    v_add_f32 v37, v37, v45
    v_add_f32 v21, v21, v37
    v_cvt_pk_bf16_f32 v21, v21, v21
    v_add_f32 v22, v22, v30
    v_add_f32 v38, v38, v46
    v_add_f32 v22, v22, v38
    v_cvt_pk_bf16_f32 v22, v22, v22
    v_add_f32 v23, v23, v31
    v_add_f32 v39, v39, v47
    v_add_f32 v23, v23, v39
    v_cvt_pk_bf16_f32 v23, v23, v23
    s_lshl_b32 s25, s24, 11
    s_lshl_b32 s26, s23, 10
    s_add_u32 s25, s25, s26
    s_lshl_b32 s26, s3, 12
    s_add_u32 s25, s25, s26
    s_add_u32 s25, s25, 25165824
    v_lshlrev_b32 v9, 8, v5
    v_lshl_add_u32 v9, v4, 1, v9
    buffer_store_short v16, v9, s[12:15], s25 offen offset:0
    buffer_store_short v17, v9, s[12:15], s25 offen offset:64
    buffer_store_short v18, v9, s[12:15], s25 offen offset:128
    buffer_store_short v19, v9, s[12:15], s25 offen offset:192
    buffer_store_short v20, v9, s[12:15], s25 offen offset:512
    buffer_store_short v21, v9, s[12:15], s25 offen offset:576
    buffer_store_short v22, v9, s[12:15], s25 offen offset:640
    buffer_store_short v23, v9, s[12:15], s25 offen offset:704
    s_waitcnt vmcnt(0)
    s_endpgm
L_mid_kernel_r1:
    s_endpgm
.text
.globl gemm2_kernel
.p2align 8
.type gemm2_kernel,@function
gemm2_kernel:
    s_cmp_ge_u32 s2, 224
    s_cbranch_scc1 L_g2_end
    s_mov_b32 s3, s2
    s_load_dwordx2 s[4:5], s[0:1], 88
    s_load_dwordx2 s[6:7], s[0:1], 112
    s_load_dwordx2 s[16:17], s[0:1], 48
    s_load_dwordx2 s[18:19], s[0:1], 0
    s_load_dwordx2 s[32:33], s[0:1], 96
    s_lshr_b32 s21, s2, 3
    s_mul_hi_u32 s20, s21, 613566757
    s_mul_i32 s23, s20, 7
    s_sub_u32 s21, s21, s23
    s_lshl_b32 s20, s20, 3
    s_and_b32 s23, s2, 7
    s_add_u32 s20, s20, s23
    v_and_b32 v1, 63, v0
    v_lshrrev_b32 v2, 6, v0
    s_nop 0
    v_readfirstlane_b32 s22, v2
    s_waitcnt lgkmcnt(0)
    s_mov_b32 s8, s4
    s_and_b32 s9, s5, 0xffff
    s_mov_b32 s10, 896
    s_mov_b32 s11, 0x00020000
    s_mov_b32 s12, s6
    s_and_b32 s13, s7, 0xffff
    s_mov_b32 s14, 268435456
    s_mov_b32 s15, 0x00020000
    s_mov_b32 s36, s16
    s_and_b32 s37, s17, 0xffff
    s_mov_b32 s38, 896
    s_mov_b32 s39, 0x00020000
    s_mov_b32 s40, s18
    s_and_b32 s41, s19, 0xffff
    s_mov_b32 s42, 1835008
    s_mov_b32 s43, 0x00020000
    s_mov_b32 s44, s32
    s_and_b32 s45, s33, 0xffff
    s_mov_b32 s46, 1835008
    s_mov_b32 s47, 0x00020000
    s_lshr_b32 s23, s22, 1
    s_and_b32 s24, s22, 1
    v_lshrrev_b32 v3, 4, v0
    v_and_b32 v4, 15, v0
    v_mul_u32_u24 v5, 3584, v3
    v_lshl_add_u32 v5, v4, 4, v5
    s_mul_i32 s25, s20, 64*3584
    s_add_u32 s25, s25, 16777216
    s_mul_i32 s26, s21, 64*3584
    s_add_u32 s26, s26, 6291456
    v_add_u32 v6, 0, v5
    v_add_u32 v7, 57344, v5
    v_add_u32 v8, 114688, v5
    v_add_u32 v9, 172032, v5
    v_mul_u32_u24 v10, 272, v3
    v_lshl_add_u32 v10, v4, 4, v10
    v_and_b32 v11, 31, v1
    v_lshrrev_b32 v12, 5, v1
    v_mul_u32_u24 v13, 272, v11
    v_lshl_add_u32 v13, v12, 4, v13
    s_mul_i32 s27, s23, 32*272
    s_mul_i32 s28, s24, 32*272
    s_add_u32 s28, s28, 17408
    v_add_u32 v14, s27, v13
    v_add_u32 v15, s28, v13
    buffer_load_dwordx4 v[80:83], v6, s[12:15], s25 offen
    buffer_load_dwordx4 v[84:87], v7, s[12:15], s25 offen
    buffer_load_dwordx4 v[88:91], v8, s[12:15], s25 offen
    buffer_load_dwordx4 v[92:95], v9, s[12:15], s25 offen
    buffer_load_dwordx4 v[96:99], v6, s[12:15], s26 offen
    buffer_load_dwordx4 v[100:103], v7, s[12:15], s26 offen
    buffer_load_dwordx4 v[104:107], v8, s[12:15], s26 offen
    buffer_load_dwordx4 v[108:111], v9, s[12:15], s26 offen
    s_add_u32 s25, s25, 256
    s_add_u32 s26, s26, 256
    buffer_load_dwordx4 v[112:115], v6, s[12:15], s25 offen
    buffer_load_dwordx4 v[116:119], v7, s[12:15], s25 offen
    buffer_load_dwordx4 v[120:123], v8, s[12:15], s25 offen
    buffer_load_dwordx4 v[124:127], v9, s[12:15], s25 offen
    buffer_load_dwordx4 v[128:131], v6, s[12:15], s26 offen
    buffer_load_dwordx4 v[132:135], v7, s[12:15], s26 offen
    buffer_load_dwordx4 v[136:139], v8, s[12:15], s26 offen
    buffer_load_dwordx4 v[140:143], v9, s[12:15], s26 offen
    s_add_u32 s25, s25, 256
    s_add_u32 s26, s26, 256
    s_lshl_b32 s29, s21, 6
    s_lshl_b32 s30, s24, 5
    s_add_u32 s29, s29, s30
    v_add_u32 v16, s29, v11
    v_lshlrev_b32 v17, 1, v16
    buffer_load_ushort v18, v17, s[8:11], 0 offen
    buffer_load_ushort v19, v17, s[36:39], 0 offen
    s_lshl_b32 s29, s20, 6
    s_lshl_b32 s30, s23, 5
    s_add_u32 s29, s29, s30
    v_lshlrev_b32 v20, 2, v12
    v_add_u32 v20, s29, v20
    v_lshlrev_b32 v21, 12, v16
    v_lshl_add_u32 v21, v20, 1, v21
    v_add_u32 v21, 25165824, v21
    buffer_load_dwordx2 v[24:25], v21, s[12:15], 0 offen offset:0
    buffer_load_dwordx2 v[26:27], v21, s[12:15], 0 offen offset:16
    buffer_load_dwordx2 v[28:29], v21, s[12:15], 0 offen offset:32
    buffer_load_dwordx2 v[30:31], v21, s[12:15], 0 offen offset:48
    v_mul_u32_u24 v22, 896, v20
    v_add_u32 v22, v22, v17
    s_mov_b32 s29, 0
    buffer_load_ushort v32, v22, s[12:15], s29 offen
    buffer_load_ushort v48, v22, s[40:43], s29 offen
    s_mov_b32 s29, 896
    buffer_load_ushort v33, v22, s[12:15], s29 offen
    buffer_load_ushort v49, v22, s[40:43], s29 offen
    s_mov_b32 s29, 1792
    buffer_load_ushort v34, v22, s[12:15], s29 offen
    buffer_load_ushort v50, v22, s[40:43], s29 offen
    s_mov_b32 s29, 2688
    buffer_load_ushort v35, v22, s[12:15], s29 offen
    buffer_load_ushort v51, v22, s[40:43], s29 offen
    s_mov_b32 s29, 7168
    buffer_load_ushort v36, v22, s[12:15], s29 offen
    buffer_load_ushort v52, v22, s[40:43], s29 offen
    s_mov_b32 s29, 8064
    buffer_load_ushort v37, v22, s[12:15], s29 offen
    buffer_load_ushort v53, v22, s[40:43], s29 offen
    s_mov_b32 s29, 8960
    buffer_load_ushort v38, v22, s[12:15], s29 offen
    buffer_load_ushort v54, v22, s[40:43], s29 offen
    s_mov_b32 s29, 9856
    buffer_load_ushort v39, v22, s[12:15], s29 offen
    buffer_load_ushort v55, v22, s[40:43], s29 offen
    s_mov_b32 s29, 14336
    buffer_load_ushort v40, v22, s[12:15], s29 offen
    buffer_load_ushort v56, v22, s[40:43], s29 offen
    s_mov_b32 s29, 15232
    buffer_load_ushort v41, v22, s[12:15], s29 offen
    buffer_load_ushort v57, v22, s[40:43], s29 offen
    s_mov_b32 s29, 16128
    buffer_load_ushort v42, v22, s[12:15], s29 offen
    buffer_load_ushort v58, v22, s[40:43], s29 offen
    s_mov_b32 s29, 17024
    buffer_load_ushort v43, v22, s[12:15], s29 offen
    buffer_load_ushort v59, v22, s[40:43], s29 offen
    s_mov_b32 s29, 21504
    buffer_load_ushort v44, v22, s[12:15], s29 offen
    buffer_load_ushort v60, v22, s[40:43], s29 offen
    s_mov_b32 s29, 22400
    buffer_load_ushort v45, v22, s[12:15], s29 offen
    buffer_load_ushort v61, v22, s[40:43], s29 offen
    s_mov_b32 s29, 23296
    buffer_load_ushort v46, v22, s[12:15], s29 offen
    buffer_load_ushort v62, v22, s[40:43], s29 offen
    s_mov_b32 s29, 24192
    buffer_load_ushort v47, v22, s[12:15], s29 offen
    buffer_load_ushort v63, v22, s[40:43], s29 offen
    v_mov_b32 v64, 0
    v_mov_b32 v65, 0
    v_mov_b32 v66, 0
    v_mov_b32 v67, 0
    v_mov_b32 v68, 0
    v_mov_b32 v69, 0
    v_mov_b32 v70, 0
    v_mov_b32 v71, 0
    v_mov_b32 v72, 0
    v_mov_b32 v73, 0
    v_mov_b32 v74, 0
    v_mov_b32 v75, 0
    v_mov_b32 v76, 0
    v_mov_b32 v77, 0
    v_mov_b32 v78, 0
    v_mov_b32 v79, 0
    s_waitcnt vmcnt(46)
    ds_write_b128 v10, v[80:83] offset:0
    ds_write_b128 v10, v[84:87] offset:4352
    ds_write_b128 v10, v[88:91] offset:8704
    ds_write_b128 v10, v[92:95] offset:13056
    ds_write_b128 v10, v[96:99] offset:17408
    ds_write_b128 v10, v[100:103] offset:21760
    ds_write_b128 v10, v[104:107] offset:26112
    ds_write_b128 v10, v[108:111] offset:30464
    s_waitcnt lgkmcnt(0)
    s_barrier
    buffer_load_dwordx4 v[80:83], v6, s[12:15], s25 offen
    buffer_load_dwordx4 v[84:87], v7, s[12:15], s25 offen
    buffer_load_dwordx4 v[88:91], v8, s[12:15], s25 offen
    buffer_load_dwordx4 v[92:95], v9, s[12:15], s25 offen
    buffer_load_dwordx4 v[96:99], v6, s[12:15], s26 offen
    buffer_load_dwordx4 v[100:103], v7, s[12:15], s26 offen
    buffer_load_dwordx4 v[104:107], v8, s[12:15], s26 offen
    buffer_load_dwordx4 v[108:111], v9, s[12:15], s26 offen
    s_add_u32 s25, s25, 256
    s_add_u32 s26, s26, 256
    ds_read_b128 v[144:147], v14 offset:0
    ds_read_b128 v[148:151], v15 offset:0
    ds_read_b128 v[152:155], v14 offset:32
    ds_read_b128 v[156:159], v15 offset:32
    ds_read_b128 v[160:163], v14 offset:64
    ds_read_b128 v[164:167], v15 offset:64
    ds_read_b128 v[168:171], v14 offset:96
    ds_read_b128 v[172:175], v15 offset:96
    ds_read_b128 v[176:179], v14 offset:128
    ds_read_b128 v[180:183], v15 offset:128
    ds_read_b128 v[184:187], v14 offset:160
    ds_read_b128 v[188:191], v15 offset:160
    ds_read_b128 v[192:195], v14 offset:192
    ds_read_b128 v[196:199], v15 offset:192
    ds_read_b128 v[200:203], v14 offset:224
    ds_read_b128 v[204:207], v15 offset:224
    s_waitcnt lgkmcnt(14)
    v_mfma_f32_32x32x16_bf16 v[64:79], v[144:147], v[148:151], v[64:79]
    s_waitcnt lgkmcnt(12)
    v_mfma_f32_32x32x16_bf16 v[64:79], v[152:155], v[156:159], v[64:79]
    s_waitcnt lgkmcnt(10)
    v_mfma_f32_32x32x16_bf16 v[64:79], v[160:163], v[164:167], v[64:79]
    s_waitcnt lgkmcnt(8)
    v_mfma_f32_32x32x16_bf16 v[64:79], v[168:171], v[172:175], v[64:79]
    s_waitcnt lgkmcnt(6)
    v_mfma_f32_32x32x16_bf16 v[64:79], v[176:179], v[180:183], v[64:79]
    s_waitcnt lgkmcnt(4)
    v_mfma_f32_32x32x16_bf16 v[64:79], v[184:187], v[188:191], v[64:79]
    s_waitcnt lgkmcnt(2)
    v_mfma_f32_32x32x16_bf16 v[64:79], v[192:195], v[196:199], v[64:79]
    s_waitcnt lgkmcnt(0)
    v_mfma_f32_32x32x16_bf16 v[64:79], v[200:203], v[204:207], v[64:79]
    s_waitcnt vmcnt(46)
    ds_write_b128 v10, v[112:115] offset:34816
    ds_write_b128 v10, v[116:119] offset:39168
    ds_write_b128 v10, v[120:123] offset:43520
    ds_write_b128 v10, v[124:127] offset:47872
    ds_write_b128 v10, v[128:131] offset:52224
    ds_write_b128 v10, v[132:135] offset:56576
    ds_write_b128 v10, v[136:139] offset:60928
    ds_write_b128 v10, v[140:143] offset:65280
    s_waitcnt lgkmcnt(0)
    s_barrier
    buffer_load_dwordx4 v[112:115], v6, s[12:15], s25 offen
    buffer_load_dwordx4 v[116:119], v7, s[12:15], s25 offen
    buffer_load_dwordx4 v[120:123], v8, s[12:15], s25 offen
    buffer_load_dwordx4 v[124:127], v9, s[12:15], s25 offen
    buffer_load_dwordx4 v[128:131], v6, s[12:15], s26 offen
    buffer_load_dwordx4 v[132:135], v7, s[12:15], s26 offen
    buffer_load_dwordx4 v[136:139], v8, s[12:15], s26 offen
    buffer_load_dwordx4 v[140:143], v9, s[12:15], s26 offen
    s_add_u32 s25, s25, 256
    s_add_u32 s26, s26, 256
    ds_read_b128 v[144:147], v14 offset:34816
    ds_read_b128 v[148:151], v15 offset:34816
    ds_read_b128 v[152:155], v14 offset:34848
    ds_read_b128 v[156:159], v15 offset:34848
    ds_read_b128 v[160:163], v14 offset:34880
    ds_read_b128 v[164:167], v15 offset:34880
    ds_read_b128 v[168:171], v14 offset:34912
    ds_read_b128 v[172:175], v15 offset:34912
    ds_read_b128 v[176:179], v14 offset:34944
    ds_read_b128 v[180:183], v15 offset:34944
    ds_read_b128 v[184:187], v14 offset:34976
    ds_read_b128 v[188:191], v15 offset:34976
    ds_read_b128 v[192:195], v14 offset:35008
    ds_read_b128 v[196:199], v15 offset:35008
    ds_read_b128 v[200:203], v14 offset:35040
    ds_read_b128 v[204:207], v15 offset:35040
    s_waitcnt lgkmcnt(14)
    v_mfma_f32_32x32x16_bf16 v[64:79], v[144:147], v[148:151], v[64:79]
    s_waitcnt lgkmcnt(12)
    v_mfma_f32_32x32x16_bf16 v[64:79], v[152:155], v[156:159], v[64:79]
    s_waitcnt lgkmcnt(10)
    v_mfma_f32_32x32x16_bf16 v[64:79], v[160:163], v[164:167], v[64:79]
    s_waitcnt lgkmcnt(8)
    v_mfma_f32_32x32x16_bf16 v[64:79], v[168:171], v[172:175], v[64:79]
    s_waitcnt lgkmcnt(6)
    v_mfma_f32_32x32x16_bf16 v[64:79], v[176:179], v[180:183], v[64:79]
    s_waitcnt lgkmcnt(4)
    v_mfma_f32_32x32x16_bf16 v[64:79], v[184:187], v[188:191], v[64:79]
    s_waitcnt lgkmcnt(2)
    v_mfma_f32_32x32x16_bf16 v[64:79], v[192:195], v[196:199], v[64:79]
    s_waitcnt lgkmcnt(0)
    v_mfma_f32_32x32x16_bf16 v[64:79], v[200:203], v[204:207], v[64:79]
    s_waitcnt vmcnt(8)
    ds_write_b128 v10, v[80:83] offset:0
    ds_write_b128 v10, v[84:87] offset:4352
    ds_write_b128 v10, v[88:91] offset:8704
    ds_write_b128 v10, v[92:95] offset:13056
    ds_write_b128 v10, v[96:99] offset:17408
    ds_write_b128 v10, v[100:103] offset:21760
    ds_write_b128 v10, v[104:107] offset:26112
    ds_write_b128 v10, v[108:111] offset:30464
    s_waitcnt lgkmcnt(0)
    s_barrier
    buffer_load_dwordx4 v[80:83], v6, s[12:15], s25 offen
    buffer_load_dwordx4 v[84:87], v7, s[12:15], s25 offen
    buffer_load_dwordx4 v[88:91], v8, s[12:15], s25 offen
    buffer_load_dwordx4 v[92:95], v9, s[12:15], s25 offen
    buffer_load_dwordx4 v[96:99], v6, s[12:15], s26 offen
    buffer_load_dwordx4 v[100:103], v7, s[12:15], s26 offen
    buffer_load_dwordx4 v[104:107], v8, s[12:15], s26 offen
    buffer_load_dwordx4 v[108:111], v9, s[12:15], s26 offen
    s_add_u32 s25, s25, 256
    s_add_u32 s26, s26, 256
    ds_read_b128 v[144:147], v14 offset:0
    ds_read_b128 v[148:151], v15 offset:0
    ds_read_b128 v[152:155], v14 offset:32
    ds_read_b128 v[156:159], v15 offset:32
    ds_read_b128 v[160:163], v14 offset:64
    ds_read_b128 v[164:167], v15 offset:64
    ds_read_b128 v[168:171], v14 offset:96
    ds_read_b128 v[172:175], v15 offset:96
    ds_read_b128 v[176:179], v14 offset:128
    ds_read_b128 v[180:183], v15 offset:128
    ds_read_b128 v[184:187], v14 offset:160
    ds_read_b128 v[188:191], v15 offset:160
    ds_read_b128 v[192:195], v14 offset:192
    ds_read_b128 v[196:199], v15 offset:192
    ds_read_b128 v[200:203], v14 offset:224
    ds_read_b128 v[204:207], v15 offset:224
    s_waitcnt lgkmcnt(14)
    v_mfma_f32_32x32x16_bf16 v[64:79], v[144:147], v[148:151], v[64:79]
    s_waitcnt lgkmcnt(12)
    v_mfma_f32_32x32x16_bf16 v[64:79], v[152:155], v[156:159], v[64:79]
    s_waitcnt lgkmcnt(10)
    v_mfma_f32_32x32x16_bf16 v[64:79], v[160:163], v[164:167], v[64:79]
    s_waitcnt lgkmcnt(8)
    v_mfma_f32_32x32x16_bf16 v[64:79], v[168:171], v[172:175], v[64:79]
    s_waitcnt lgkmcnt(6)
    v_mfma_f32_32x32x16_bf16 v[64:79], v[176:179], v[180:183], v[64:79]
    s_waitcnt lgkmcnt(4)
    v_mfma_f32_32x32x16_bf16 v[64:79], v[184:187], v[188:191], v[64:79]
    s_waitcnt lgkmcnt(2)
    v_mfma_f32_32x32x16_bf16 v[64:79], v[192:195], v[196:199], v[64:79]
    s_waitcnt lgkmcnt(0)
    v_mfma_f32_32x32x16_bf16 v[64:79], v[200:203], v[204:207], v[64:79]
    s_waitcnt vmcnt(8)
    ds_write_b128 v10, v[112:115] offset:34816
    ds_write_b128 v10, v[116:119] offset:39168
    ds_write_b128 v10, v[120:123] offset:43520
    ds_write_b128 v10, v[124:127] offset:47872
    ds_write_b128 v10, v[128:131] offset:52224
    ds_write_b128 v10, v[132:135] offset:56576
    ds_write_b128 v10, v[136:139] offset:60928
    ds_write_b128 v10, v[140:143] offset:65280
    s_waitcnt lgkmcnt(0)
    s_barrier
    buffer_load_dwordx4 v[112:115], v6, s[12:15], s25 offen
    buffer_load_dwordx4 v[116:119], v7, s[12:15], s25 offen
    buffer_load_dwordx4 v[120:123], v8, s[12:15], s25 offen
    buffer_load_dwordx4 v[124:127], v9, s[12:15], s25 offen
    buffer_load_dwordx4 v[128:131], v6, s[12:15], s26 offen
    buffer_load_dwordx4 v[132:135], v7, s[12:15], s26 offen
    buffer_load_dwordx4 v[136:139], v8, s[12:15], s26 offen
    buffer_load_dwordx4 v[140:143], v9, s[12:15], s26 offen
    s_add_u32 s25, s25, 256
    s_add_u32 s26, s26, 256
    ds_read_b128 v[144:147], v14 offset:34816
    ds_read_b128 v[148:151], v15 offset:34816
    ds_read_b128 v[152:155], v14 offset:34848
    ds_read_b128 v[156:159], v15 offset:34848
    ds_read_b128 v[160:163], v14 offset:34880
    ds_read_b128 v[164:167], v15 offset:34880
    ds_read_b128 v[168:171], v14 offset:34912
    ds_read_b128 v[172:175], v15 offset:34912
    ds_read_b128 v[176:179], v14 offset:34944
    ds_read_b128 v[180:183], v15 offset:34944
    ds_read_b128 v[184:187], v14 offset:34976
    ds_read_b128 v[188:191], v15 offset:34976
    ds_read_b128 v[192:195], v14 offset:35008
    ds_read_b128 v[196:199], v15 offset:35008
    ds_read_b128 v[200:203], v14 offset:35040
    ds_read_b128 v[204:207], v15 offset:35040
    s_waitcnt lgkmcnt(14)
    v_mfma_f32_32x32x16_bf16 v[64:79], v[144:147], v[148:151], v[64:79]
    s_waitcnt lgkmcnt(12)
    v_mfma_f32_32x32x16_bf16 v[64:79], v[152:155], v[156:159], v[64:79]
    s_waitcnt lgkmcnt(10)
    v_mfma_f32_32x32x16_bf16 v[64:79], v[160:163], v[164:167], v[64:79]
    s_waitcnt lgkmcnt(8)
    v_mfma_f32_32x32x16_bf16 v[64:79], v[168:171], v[172:175], v[64:79]
    s_waitcnt lgkmcnt(6)
    v_mfma_f32_32x32x16_bf16 v[64:79], v[176:179], v[180:183], v[64:79]
    s_waitcnt lgkmcnt(4)
    v_mfma_f32_32x32x16_bf16 v[64:79], v[184:187], v[188:191], v[64:79]
    s_waitcnt lgkmcnt(2)
    v_mfma_f32_32x32x16_bf16 v[64:79], v[192:195], v[196:199], v[64:79]
    s_waitcnt lgkmcnt(0)
    v_mfma_f32_32x32x16_bf16 v[64:79], v[200:203], v[204:207], v[64:79]
    s_waitcnt vmcnt(8)
    ds_write_b128 v10, v[80:83] offset:0
    ds_write_b128 v10, v[84:87] offset:4352
    ds_write_b128 v10, v[88:91] offset:8704
    ds_write_b128 v10, v[92:95] offset:13056
    ds_write_b128 v10, v[96:99] offset:17408
    ds_write_b128 v10, v[100:103] offset:21760
    ds_write_b128 v10, v[104:107] offset:26112
    ds_write_b128 v10, v[108:111] offset:30464
    s_waitcnt lgkmcnt(0)
    s_barrier
    buffer_load_dwordx4 v[80:83], v6, s[12:15], s25 offen
    buffer_load_dwordx4 v[84:87], v7, s[12:15], s25 offen
    buffer_load_dwordx4 v[88:91], v8, s[12:15], s25 offen
    buffer_load_dwordx4 v[92:95], v9, s[12:15], s25 offen
    buffer_load_dwordx4 v[96:99], v6, s[12:15], s26 offen
    buffer_load_dwordx4 v[100:103], v7, s[12:15], s26 offen
    buffer_load_dwordx4 v[104:107], v8, s[12:15], s26 offen
    buffer_load_dwordx4 v[108:111], v9, s[12:15], s26 offen
    s_add_u32 s25, s25, 256
    s_add_u32 s26, s26, 256
    ds_read_b128 v[144:147], v14 offset:0
    ds_read_b128 v[148:151], v15 offset:0
    ds_read_b128 v[152:155], v14 offset:32
    ds_read_b128 v[156:159], v15 offset:32
    ds_read_b128 v[160:163], v14 offset:64
    ds_read_b128 v[164:167], v15 offset:64
    ds_read_b128 v[168:171], v14 offset:96
    ds_read_b128 v[172:175], v15 offset:96
    ds_read_b128 v[176:179], v14 offset:128
    ds_read_b128 v[180:183], v15 offset:128
    ds_read_b128 v[184:187], v14 offset:160
    ds_read_b128 v[188:191], v15 offset:160
    ds_read_b128 v[192:195], v14 offset:192
    ds_read_b128 v[196:199], v15 offset:192
    ds_read_b128 v[200:203], v14 offset:224
    ds_read_b128 v[204:207], v15 offset:224
    s_waitcnt lgkmcnt(14)
    v_mfma_f32_32x32x16_bf16 v[64:79], v[144:147], v[148:151], v[64:79]
    s_waitcnt lgkmcnt(12)
    v_mfma_f32_32x32x16_bf16 v[64:79], v[152:155], v[156:159], v[64:79]
    s_waitcnt lgkmcnt(10)
    v_mfma_f32_32x32x16_bf16 v[64:79], v[160:163], v[164:167], v[64:79]
    s_waitcnt lgkmcnt(8)
    v_mfma_f32_32x32x16_bf16 v[64:79], v[168:171], v[172:175], v[64:79]
    s_waitcnt lgkmcnt(6)
    v_mfma_f32_32x32x16_bf16 v[64:79], v[176:179], v[180:183], v[64:79]
    s_waitcnt lgkmcnt(4)
    v_mfma_f32_32x32x16_bf16 v[64:79], v[184:187], v[188:191], v[64:79]
    s_waitcnt lgkmcnt(2)
    v_mfma_f32_32x32x16_bf16 v[64:79], v[192:195], v[196:199], v[64:79]
    s_waitcnt lgkmcnt(0)
    v_mfma_f32_32x32x16_bf16 v[64:79], v[200:203], v[204:207], v[64:79]
    s_waitcnt vmcnt(8)
    ds_write_b128 v10, v[112:115] offset:34816
    ds_write_b128 v10, v[116:119] offset:39168
    ds_write_b128 v10, v[120:123] offset:43520
    ds_write_b128 v10, v[124:127] offset:47872
    ds_write_b128 v10, v[128:131] offset:52224
    ds_write_b128 v10, v[132:135] offset:56576
    ds_write_b128 v10, v[136:139] offset:60928
    ds_write_b128 v10, v[140:143] offset:65280
    s_waitcnt lgkmcnt(0)
    s_barrier
    buffer_load_dwordx4 v[112:115], v6, s[12:15], s25 offen
    buffer_load_dwordx4 v[116:119], v7, s[12:15], s25 offen
    buffer_load_dwordx4 v[120:123], v8, s[12:15], s25 offen
    buffer_load_dwordx4 v[124:127], v9, s[12:15], s25 offen
    buffer_load_dwordx4 v[128:131], v6, s[12:15], s26 offen
    buffer_load_dwordx4 v[132:135], v7, s[12:15], s26 offen
    buffer_load_dwordx4 v[136:139], v8, s[12:15], s26 offen
    buffer_load_dwordx4 v[140:143], v9, s[12:15], s26 offen
    s_add_u32 s25, s25, 256
    s_add_u32 s26, s26, 256
    ds_read_b128 v[144:147], v14 offset:34816
    ds_read_b128 v[148:151], v15 offset:34816
    ds_read_b128 v[152:155], v14 offset:34848
    ds_read_b128 v[156:159], v15 offset:34848
    ds_read_b128 v[160:163], v14 offset:34880
    ds_read_b128 v[164:167], v15 offset:34880
    ds_read_b128 v[168:171], v14 offset:34912
    ds_read_b128 v[172:175], v15 offset:34912
    ds_read_b128 v[176:179], v14 offset:34944
    ds_read_b128 v[180:183], v15 offset:34944
    ds_read_b128 v[184:187], v14 offset:34976
    ds_read_b128 v[188:191], v15 offset:34976
    ds_read_b128 v[192:195], v14 offset:35008
    ds_read_b128 v[196:199], v15 offset:35008
    ds_read_b128 v[200:203], v14 offset:35040
    ds_read_b128 v[204:207], v15 offset:35040
    s_waitcnt lgkmcnt(14)
    v_mfma_f32_32x32x16_bf16 v[64:79], v[144:147], v[148:151], v[64:79]
    s_waitcnt lgkmcnt(12)
    v_mfma_f32_32x32x16_bf16 v[64:79], v[152:155], v[156:159], v[64:79]
    s_waitcnt lgkmcnt(10)
    v_mfma_f32_32x32x16_bf16 v[64:79], v[160:163], v[164:167], v[64:79]
    s_waitcnt lgkmcnt(8)
    v_mfma_f32_32x32x16_bf16 v[64:79], v[168:171], v[172:175], v[64:79]
    s_waitcnt lgkmcnt(6)
    v_mfma_f32_32x32x16_bf16 v[64:79], v[176:179], v[180:183], v[64:79]
    s_waitcnt lgkmcnt(4)
    v_mfma_f32_32x32x16_bf16 v[64:79], v[184:187], v[188:191], v[64:79]
    s_waitcnt lgkmcnt(2)
    v_mfma_f32_32x32x16_bf16 v[64:79], v[192:195], v[196:199], v[64:79]
    s_waitcnt lgkmcnt(0)
    v_mfma_f32_32x32x16_bf16 v[64:79], v[200:203], v[204:207], v[64:79]
    s_waitcnt vmcnt(8)
    ds_write_b128 v10, v[80:83] offset:0
    ds_write_b128 v10, v[84:87] offset:4352
    ds_write_b128 v10, v[88:91] offset:8704
    ds_write_b128 v10, v[92:95] offset:13056
    ds_write_b128 v10, v[96:99] offset:17408
    ds_write_b128 v10, v[100:103] offset:21760
    ds_write_b128 v10, v[104:107] offset:26112
    ds_write_b128 v10, v[108:111] offset:30464
    s_waitcnt lgkmcnt(0)
    s_barrier
    buffer_load_dwordx4 v[80:83], v6, s[12:15], s25 offen
    buffer_load_dwordx4 v[84:87], v7, s[12:15], s25 offen
    buffer_load_dwordx4 v[88:91], v8, s[12:15], s25 offen
    buffer_load_dwordx4 v[92:95], v9, s[12:15], s25 offen
    buffer_load_dwordx4 v[96:99], v6, s[12:15], s26 offen
    buffer_load_dwordx4 v[100:103], v7, s[12:15], s26 offen
    buffer_load_dwordx4 v[104:107], v8, s[12:15], s26 offen
    buffer_load_dwordx4 v[108:111], v9, s[12:15], s26 offen
    s_add_u32 s25, s25, 256
    s_add_u32 s26, s26, 256
    ds_read_b128 v[144:147], v14 offset:0
    ds_read_b128 v[148:151], v15 offset:0
    ds_read_b128 v[152:155], v14 offset:32
    ds_read_b128 v[156:159], v15 offset:32
    ds_read_b128 v[160:163], v14 offset:64
    ds_read_b128 v[164:167], v15 offset:64
    ds_read_b128 v[168:171], v14 offset:96
    ds_read_b128 v[172:175], v15 offset:96
    ds_read_b128 v[176:179], v14 offset:128
    ds_read_b128 v[180:183], v15 offset:128
    ds_read_b128 v[184:187], v14 offset:160
    ds_read_b128 v[188:191], v15 offset:160
    ds_read_b128 v[192:195], v14 offset:192
    ds_read_b128 v[196:199], v15 offset:192
    ds_read_b128 v[200:203], v14 offset:224
    ds_read_b128 v[204:207], v15 offset:224
    s_waitcnt lgkmcnt(14)
    v_mfma_f32_32x32x16_bf16 v[64:79], v[144:147], v[148:151], v[64:79]
    s_waitcnt lgkmcnt(12)
    v_mfma_f32_32x32x16_bf16 v[64:79], v[152:155], v[156:159], v[64:79]
    s_waitcnt lgkmcnt(10)
    v_mfma_f32_32x32x16_bf16 v[64:79], v[160:163], v[164:167], v[64:79]
    s_waitcnt lgkmcnt(8)
    v_mfma_f32_32x32x16_bf16 v[64:79], v[168:171], v[172:175], v[64:79]
    s_waitcnt lgkmcnt(6)
    v_mfma_f32_32x32x16_bf16 v[64:79], v[176:179], v[180:183], v[64:79]
    s_waitcnt lgkmcnt(4)
    v_mfma_f32_32x32x16_bf16 v[64:79], v[184:187], v[188:191], v[64:79]
    s_waitcnt lgkmcnt(2)
    v_mfma_f32_32x32x16_bf16 v[64:79], v[192:195], v[196:199], v[64:79]
    s_waitcnt lgkmcnt(0)
    v_mfma_f32_32x32x16_bf16 v[64:79], v[200:203], v[204:207], v[64:79]
    s_waitcnt vmcnt(8)
    ds_write_b128 v10, v[112:115] offset:34816
    ds_write_b128 v10, v[116:119] offset:39168
    ds_write_b128 v10, v[120:123] offset:43520
    ds_write_b128 v10, v[124:127] offset:47872
    ds_write_b128 v10, v[128:131] offset:52224
    ds_write_b128 v10, v[132:135] offset:56576
    ds_write_b128 v10, v[136:139] offset:60928
    ds_write_b128 v10, v[140:143] offset:65280
    s_waitcnt lgkmcnt(0)
    s_barrier
    buffer_load_dwordx4 v[112:115], v6, s[12:15], s25 offen
    buffer_load_dwordx4 v[116:119], v7, s[12:15], s25 offen
    buffer_load_dwordx4 v[120:123], v8, s[12:15], s25 offen
    buffer_load_dwordx4 v[124:127], v9, s[12:15], s25 offen
    buffer_load_dwordx4 v[128:131], v6, s[12:15], s26 offen
    buffer_load_dwordx4 v[132:135], v7, s[12:15], s26 offen
    buffer_load_dwordx4 v[136:139], v8, s[12:15], s26 offen
    buffer_load_dwordx4 v[140:143], v9, s[12:15], s26 offen
    s_add_u32 s25, s25, 256
    s_add_u32 s26, s26, 256
    ds_read_b128 v[144:147], v14 offset:34816
    ds_read_b128 v[148:151], v15 offset:34816
    ds_read_b128 v[152:155], v14 offset:34848
    ds_read_b128 v[156:159], v15 offset:34848
    ds_read_b128 v[160:163], v14 offset:34880
    ds_read_b128 v[164:167], v15 offset:34880
    ds_read_b128 v[168:171], v14 offset:34912
    ds_read_b128 v[172:175], v15 offset:34912
    ds_read_b128 v[176:179], v14 offset:34944
    ds_read_b128 v[180:183], v15 offset:34944
    ds_read_b128 v[184:187], v14 offset:34976
    ds_read_b128 v[188:191], v15 offset:34976
    ds_read_b128 v[192:195], v14 offset:35008
    ds_read_b128 v[196:199], v15 offset:35008
    ds_read_b128 v[200:203], v14 offset:35040
    ds_read_b128 v[204:207], v15 offset:35040
    s_waitcnt lgkmcnt(14)
    v_mfma_f32_32x32x16_bf16 v[64:79], v[144:147], v[148:151], v[64:79]
    s_waitcnt lgkmcnt(12)
    v_mfma_f32_32x32x16_bf16 v[64:79], v[152:155], v[156:159], v[64:79]
    s_waitcnt lgkmcnt(10)
    v_mfma_f32_32x32x16_bf16 v[64:79], v[160:163], v[164:167], v[64:79]
    s_waitcnt lgkmcnt(8)
    v_mfma_f32_32x32x16_bf16 v[64:79], v[168:171], v[172:175], v[64:79]
    s_waitcnt lgkmcnt(6)
    v_mfma_f32_32x32x16_bf16 v[64:79], v[176:179], v[180:183], v[64:79]
    s_waitcnt lgkmcnt(4)
    v_mfma_f32_32x32x16_bf16 v[64:79], v[184:187], v[188:191], v[64:79]
    s_waitcnt lgkmcnt(2)
    v_mfma_f32_32x32x16_bf16 v[64:79], v[192:195], v[196:199], v[64:79]
    s_waitcnt lgkmcnt(0)
    v_mfma_f32_32x32x16_bf16 v[64:79], v[200:203], v[204:207], v[64:79]
    s_waitcnt vmcnt(8)
    ds_write_b128 v10, v[80:83] offset:0
    ds_write_b128 v10, v[84:87] offset:4352
    ds_write_b128 v10, v[88:91] offset:8704
    ds_write_b128 v10, v[92:95] offset:13056
    ds_write_b128 v10, v[96:99] offset:17408
    ds_write_b128 v10, v[100:103] offset:21760
    ds_write_b128 v10, v[104:107] offset:26112
    ds_write_b128 v10, v[108:111] offset:30464
    s_waitcnt lgkmcnt(0)
    s_barrier
    buffer_load_dwordx4 v[80:83], v6, s[12:15], s25 offen
    buffer_load_dwordx4 v[84:87], v7, s[12:15], s25 offen
    buffer_load_dwordx4 v[88:91], v8, s[12:15], s25 offen
    buffer_load_dwordx4 v[92:95], v9, s[12:15], s25 offen
    buffer_load_dwordx4 v[96:99], v6, s[12:15], s26 offen
    buffer_load_dwordx4 v[100:103], v7, s[12:15], s26 offen
    buffer_load_dwordx4 v[104:107], v8, s[12:15], s26 offen
    buffer_load_dwordx4 v[108:111], v9, s[12:15], s26 offen
    s_add_u32 s25, s25, 256
    s_add_u32 s26, s26, 256
    ds_read_b128 v[144:147], v14 offset:0
    ds_read_b128 v[148:151], v15 offset:0
    ds_read_b128 v[152:155], v14 offset:32
    ds_read_b128 v[156:159], v15 offset:32
    ds_read_b128 v[160:163], v14 offset:64
    ds_read_b128 v[164:167], v15 offset:64
    ds_read_b128 v[168:171], v14 offset:96
    ds_read_b128 v[172:175], v15 offset:96
    ds_read_b128 v[176:179], v14 offset:128
    ds_read_b128 v[180:183], v15 offset:128
    ds_read_b128 v[184:187], v14 offset:160
    ds_read_b128 v[188:191], v15 offset:160
    ds_read_b128 v[192:195], v14 offset:192
    ds_read_b128 v[196:199], v15 offset:192
    ds_read_b128 v[200:203], v14 offset:224
    ds_read_b128 v[204:207], v15 offset:224
    s_waitcnt lgkmcnt(14)
    v_mfma_f32_32x32x16_bf16 v[64:79], v[144:147], v[148:151], v[64:79]
    s_waitcnt lgkmcnt(12)
    v_mfma_f32_32x32x16_bf16 v[64:79], v[152:155], v[156:159], v[64:79]
    s_waitcnt lgkmcnt(10)
    v_mfma_f32_32x32x16_bf16 v[64:79], v[160:163], v[164:167], v[64:79]
    s_waitcnt lgkmcnt(8)
    v_mfma_f32_32x32x16_bf16 v[64:79], v[168:171], v[172:175], v[64:79]
    s_waitcnt lgkmcnt(6)
    v_mfma_f32_32x32x16_bf16 v[64:79], v[176:179], v[180:183], v[64:79]
    s_waitcnt lgkmcnt(4)
    v_mfma_f32_32x32x16_bf16 v[64:79], v[184:187], v[188:191], v[64:79]
    s_waitcnt lgkmcnt(2)
    v_mfma_f32_32x32x16_bf16 v[64:79], v[192:195], v[196:199], v[64:79]
    s_waitcnt lgkmcnt(0)
    v_mfma_f32_32x32x16_bf16 v[64:79], v[200:203], v[204:207], v[64:79]
    s_waitcnt vmcnt(8)
    ds_write_b128 v10, v[112:115] offset:34816
    ds_write_b128 v10, v[116:119] offset:39168
    ds_write_b128 v10, v[120:123] offset:43520
    ds_write_b128 v10, v[124:127] offset:47872
    ds_write_b128 v10, v[128:131] offset:52224
    ds_write_b128 v10, v[132:135] offset:56576
    ds_write_b128 v10, v[136:139] offset:60928
    ds_write_b128 v10, v[140:143] offset:65280
    s_waitcnt lgkmcnt(0)
    s_barrier
    buffer_load_dwordx4 v[112:115], v6, s[12:15], s25 offen
    buffer_load_dwordx4 v[116:119], v7, s[12:15], s25 offen
    buffer_load_dwordx4 v[120:123], v8, s[12:15], s25 offen
    buffer_load_dwordx4 v[124:127], v9, s[12:15], s25 offen
    buffer_load_dwordx4 v[128:131], v6, s[12:15], s26 offen
    buffer_load_dwordx4 v[132:135], v7, s[12:15], s26 offen
    buffer_load_dwordx4 v[136:139], v8, s[12:15], s26 offen
    buffer_load_dwordx4 v[140:143], v9, s[12:15], s26 offen
    s_add_u32 s25, s25, 256
    s_add_u32 s26, s26, 256
    ds_read_b128 v[144:147], v14 offset:34816
    ds_read_b128 v[148:151], v15 offset:34816
    ds_read_b128 v[152:155], v14 offset:34848
    ds_read_b128 v[156:159], v15 offset:34848
    ds_read_b128 v[160:163], v14 offset:34880
    ds_read_b128 v[164:167], v15 offset:34880
    ds_read_b128 v[168:171], v14 offset:34912
    ds_read_b128 v[172:175], v15 offset:34912
    ds_read_b128 v[176:179], v14 offset:34944
    ds_read_b128 v[180:183], v15 offset:34944
    ds_read_b128 v[184:187], v14 offset:34976
    ds_read_b128 v[188:191], v15 offset:34976
    ds_read_b128 v[192:195], v14 offset:35008
    ds_read_b128 v[196:199], v15 offset:35008
    ds_read_b128 v[200:203], v14 offset:35040
    ds_read_b128 v[204:207], v15 offset:35040
    s_waitcnt lgkmcnt(14)
    v_mfma_f32_32x32x16_bf16 v[64:79], v[144:147], v[148:151], v[64:79]
    s_waitcnt lgkmcnt(12)
    v_mfma_f32_32x32x16_bf16 v[64:79], v[152:155], v[156:159], v[64:79]
    s_waitcnt lgkmcnt(10)
    v_mfma_f32_32x32x16_bf16 v[64:79], v[160:163], v[164:167], v[64:79]
    s_waitcnt lgkmcnt(8)
    v_mfma_f32_32x32x16_bf16 v[64:79], v[168:171], v[172:175], v[64:79]
    s_waitcnt lgkmcnt(6)
    v_mfma_f32_32x32x16_bf16 v[64:79], v[176:179], v[180:183], v[64:79]
    s_waitcnt lgkmcnt(4)
    v_mfma_f32_32x32x16_bf16 v[64:79], v[184:187], v[188:191], v[64:79]
    s_waitcnt lgkmcnt(2)
    v_mfma_f32_32x32x16_bf16 v[64:79], v[192:195], v[196:199], v[64:79]
    s_waitcnt lgkmcnt(0)
    v_mfma_f32_32x32x16_bf16 v[64:79], v[200:203], v[204:207], v[64:79]
    s_waitcnt vmcnt(8)
    ds_write_b128 v10, v[80:83] offset:0
    ds_write_b128 v10, v[84:87] offset:4352
    ds_write_b128 v10, v[88:91] offset:8704
    ds_write_b128 v10, v[92:95] offset:13056
    ds_write_b128 v10, v[96:99] offset:17408
    ds_write_b128 v10, v[100:103] offset:21760
    ds_write_b128 v10, v[104:107] offset:26112
    ds_write_b128 v10, v[108:111] offset:30464
    s_waitcnt lgkmcnt(0)
    s_barrier
    buffer_load_dwordx4 v[80:83], v6, s[12:15], s25 offen
    buffer_load_dwordx4 v[84:87], v7, s[12:15], s25 offen
    buffer_load_dwordx4 v[88:91], v8, s[12:15], s25 offen
    buffer_load_dwordx4 v[92:95], v9, s[12:15], s25 offen
    buffer_load_dwordx4 v[96:99], v6, s[12:15], s26 offen
    buffer_load_dwordx4 v[100:103], v7, s[12:15], s26 offen
    buffer_load_dwordx4 v[104:107], v8, s[12:15], s26 offen
    buffer_load_dwordx4 v[108:111], v9, s[12:15], s26 offen
    s_add_u32 s25, s25, 256
    s_add_u32 s26, s26, 256
    ds_read_b128 v[144:147], v14 offset:0
    ds_read_b128 v[148:151], v15 offset:0
    ds_read_b128 v[152:155], v14 offset:32
    ds_read_b128 v[156:159], v15 offset:32
    ds_read_b128 v[160:163], v14 offset:64
    ds_read_b128 v[164:167], v15 offset:64
    ds_read_b128 v[168:171], v14 offset:96
    ds_read_b128 v[172:175], v15 offset:96
    ds_read_b128 v[176:179], v14 offset:128
    ds_read_b128 v[180:183], v15 offset:128
    ds_read_b128 v[184:187], v14 offset:160
    ds_read_b128 v[188:191], v15 offset:160
    ds_read_b128 v[192:195], v14 offset:192
    ds_read_b128 v[196:199], v15 offset:192
    ds_read_b128 v[200:203], v14 offset:224
    ds_read_b128 v[204:207], v15 offset:224
    s_waitcnt lgkmcnt(14)
    v_mfma_f32_32x32x16_bf16 v[64:79], v[144:147], v[148:151], v[64:79]
    s_waitcnt lgkmcnt(12)
    v_mfma_f32_32x32x16_bf16 v[64:79], v[152:155], v[156:159], v[64:79]
    s_waitcnt lgkmcnt(10)
    v_mfma_f32_32x32x16_bf16 v[64:79], v[160:163], v[164:167], v[64:79]
    s_waitcnt lgkmcnt(8)
    v_mfma_f32_32x32x16_bf16 v[64:79], v[168:171], v[172:175], v[64:79]
    s_waitcnt lgkmcnt(6)
    v_mfma_f32_32x32x16_bf16 v[64:79], v[176:179], v[180:183], v[64:79]
    s_waitcnt lgkmcnt(4)
    v_mfma_f32_32x32x16_bf16 v[64:79], v[184:187], v[188:191], v[64:79]
    s_waitcnt lgkmcnt(2)
    v_mfma_f32_32x32x16_bf16 v[64:79], v[192:195], v[196:199], v[64:79]
    s_waitcnt lgkmcnt(0)
    v_mfma_f32_32x32x16_bf16 v[64:79], v[200:203], v[204:207], v[64:79]
    s_waitcnt vmcnt(8)
    ds_write_b128 v10, v[112:115] offset:34816
    ds_write_b128 v10, v[116:119] offset:39168
    ds_write_b128 v10, v[120:123] offset:43520
    ds_write_b128 v10, v[124:127] offset:47872
    ds_write_b128 v10, v[128:131] offset:52224
    ds_write_b128 v10, v[132:135] offset:56576
    ds_write_b128 v10, v[136:139] offset:60928
    ds_write_b128 v10, v[140:143] offset:65280
    s_waitcnt lgkmcnt(0)
    s_barrier
    buffer_load_dwordx4 v[112:115], v6, s[12:15], s25 offen
    buffer_load_dwordx4 v[116:119], v7, s[12:15], s25 offen
    buffer_load_dwordx4 v[120:123], v8, s[12:15], s25 offen
    buffer_load_dwordx4 v[124:127], v9, s[12:15], s25 offen
    buffer_load_dwordx4 v[128:131], v6, s[12:15], s26 offen
    buffer_load_dwordx4 v[132:135], v7, s[12:15], s26 offen
    buffer_load_dwordx4 v[136:139], v8, s[12:15], s26 offen
    buffer_load_dwordx4 v[140:143], v9, s[12:15], s26 offen
    s_add_u32 s25, s25, 256
    s_add_u32 s26, s26, 256
    ds_read_b128 v[144:147], v14 offset:34816
    ds_read_b128 v[148:151], v15 offset:34816
    ds_read_b128 v[152:155], v14 offset:34848
    ds_read_b128 v[156:159], v15 offset:34848
    ds_read_b128 v[160:163], v14 offset:34880
    ds_read_b128 v[164:167], v15 offset:34880
    ds_read_b128 v[168:171], v14 offset:34912
    ds_read_b128 v[172:175], v15 offset:34912
    ds_read_b128 v[176:179], v14 offset:34944
    ds_read_b128 v[180:183], v15 offset:34944
    ds_read_b128 v[184:187], v14 offset:34976
    ds_read_b128 v[188:191], v15 offset:34976
    ds_read_b128 v[192:195], v14 offset:35008
    ds_read_b128 v[196:199], v15 offset:35008
    ds_read_b128 v[200:203], v14 offset:35040
    ds_read_b128 v[204:207], v15 offset:35040
    s_waitcnt lgkmcnt(14)
    v_mfma_f32_32x32x16_bf16 v[64:79], v[144:147], v[148:151], v[64:79]
    s_waitcnt lgkmcnt(12)
    v_mfma_f32_32x32x16_bf16 v[64:79], v[152:155], v[156:159], v[64:79]
    s_waitcnt lgkmcnt(10)
    v_mfma_f32_32x32x16_bf16 v[64:79], v[160:163], v[164:167], v[64:79]
    s_waitcnt lgkmcnt(8)
    v_mfma_f32_32x32x16_bf16 v[64:79], v[168:171], v[172:175], v[64:79]
    s_waitcnt lgkmcnt(6)
    v_mfma_f32_32x32x16_bf16 v[64:79], v[176:179], v[180:183], v[64:79]
    s_waitcnt lgkmcnt(4)
    v_mfma_f32_32x32x16_bf16 v[64:79], v[184:187], v[188:191], v[64:79]
    s_waitcnt lgkmcnt(2)
    v_mfma_f32_32x32x16_bf16 v[64:79], v[192:195], v[196:199], v[64:79]
    s_waitcnt lgkmcnt(0)
    v_mfma_f32_32x32x16_bf16 v[64:79], v[200:203], v[204:207], v[64:79]
    s_waitcnt vmcnt(8)
    ds_write_b128 v10, v[80:83] offset:0
    ds_write_b128 v10, v[84:87] offset:4352
    ds_write_b128 v10, v[88:91] offset:8704
    ds_write_b128 v10, v[92:95] offset:13056
    ds_write_b128 v10, v[96:99] offset:17408
    ds_write_b128 v10, v[100:103] offset:21760
    ds_write_b128 v10, v[104:107] offset:26112
    ds_write_b128 v10, v[108:111] offset:30464
    s_waitcnt lgkmcnt(0)
    s_barrier
    ds_read_b128 v[144:147], v14 offset:0
    ds_read_b128 v[148:151], v15 offset:0
    ds_read_b128 v[152:155], v14 offset:32
    ds_read_b128 v[156:159], v15 offset:32
    ds_read_b128 v[160:163], v14 offset:64
    ds_read_b128 v[164:167], v15 offset:64
    ds_read_b128 v[168:171], v14 offset:96
    ds_read_b128 v[172:175], v15 offset:96
    ds_read_b128 v[176:179], v14 offset:128
    ds_read_b128 v[180:183], v15 offset:128
    ds_read_b128 v[184:187], v14 offset:160
    ds_read_b128 v[188:191], v15 offset:160
    ds_read_b128 v[192:195], v14 offset:192
    ds_read_b128 v[196:199], v15 offset:192
    ds_read_b128 v[200:203], v14 offset:224
    ds_read_b128 v[204:207], v15 offset:224
    s_waitcnt lgkmcnt(14)
    v_mfma_f32_32x32x16_bf16 v[64:79], v[144:147], v[148:151], v[64:79]
    s_waitcnt lgkmcnt(12)
    v_mfma_f32_32x32x16_bf16 v[64:79], v[152:155], v[156:159], v[64:79]
    s_waitcnt lgkmcnt(10)
    v_mfma_f32_32x32x16_bf16 v[64:79], v[160:163], v[164:167], v[64:79]
    s_waitcnt lgkmcnt(8)
    v_mfma_f32_32x32x16_bf16 v[64:79], v[168:171], v[172:175], v[64:79]
    s_waitcnt lgkmcnt(6)
    v_mfma_f32_32x32x16_bf16 v[64:79], v[176:179], v[180:183], v[64:79]
    s_waitcnt lgkmcnt(4)
    v_mfma_f32_32x32x16_bf16 v[64:79], v[184:187], v[188:191], v[64:79]
    s_waitcnt lgkmcnt(2)
    v_mfma_f32_32x32x16_bf16 v[64:79], v[192:195], v[196:199], v[64:79]
    s_waitcnt lgkmcnt(0)
    v_mfma_f32_32x32x16_bf16 v[64:79], v[200:203], v[204:207], v[64:79]
    s_waitcnt vmcnt(0)
    ds_write_b128 v10, v[112:115] offset:34816
    ds_write_b128 v10, v[116:119] offset:39168
    ds_write_b128 v10, v[120:123] offset:43520
    ds_write_b128 v10, v[124:127] offset:47872
    ds_write_b128 v10, v[128:131] offset:52224
    ds_write_b128 v10, v[132:135] offset:56576
    ds_write_b128 v10, v[136:139] offset:60928
    ds_write_b128 v10, v[140:143] offset:65280
    s_waitcnt lgkmcnt(0)
    s_barrier
    ds_read_b128 v[144:147], v14 offset:34816
    ds_read_b128 v[148:151], v15 offset:34816
    ds_read_b128 v[152:155], v14 offset:34848
    ds_read_b128 v[156:159], v15 offset:34848
    ds_read_b128 v[160:163], v14 offset:34880
    ds_read_b128 v[164:167], v15 offset:34880
    ds_read_b128 v[168:171], v14 offset:34912
    ds_read_b128 v[172:175], v15 offset:34912
    ds_read_b128 v[176:179], v14 offset:34944
    ds_read_b128 v[180:183], v15 offset:34944
    ds_read_b128 v[184:187], v14 offset:34976
    ds_read_b128 v[188:191], v15 offset:34976
    ds_read_b128 v[192:195], v14 offset:35008
    ds_read_b128 v[196:199], v15 offset:35008
    ds_read_b128 v[200:203], v14 offset:35040
    ds_read_b128 v[204:207], v15 offset:35040
    s_waitcnt lgkmcnt(14)
    v_mfma_f32_32x32x16_bf16 v[64:79], v[144:147], v[148:151], v[64:79]
    s_waitcnt lgkmcnt(12)
    v_mfma_f32_32x32x16_bf16 v[64:79], v[152:155], v[156:159], v[64:79]
    s_waitcnt lgkmcnt(10)
    v_mfma_f32_32x32x16_bf16 v[64:79], v[160:163], v[164:167], v[64:79]
    s_waitcnt lgkmcnt(8)
    v_mfma_f32_32x32x16_bf16 v[64:79], v[168:171], v[172:175], v[64:79]
    s_waitcnt lgkmcnt(6)
    v_mfma_f32_32x32x16_bf16 v[64:79], v[176:179], v[180:183], v[64:79]
    s_waitcnt lgkmcnt(4)
    v_mfma_f32_32x32x16_bf16 v[64:79], v[184:187], v[188:191], v[64:79]
    s_waitcnt lgkmcnt(2)
    v_mfma_f32_32x32x16_bf16 v[64:79], v[192:195], v[196:199], v[64:79]
    s_waitcnt lgkmcnt(0)
    v_mfma_f32_32x32x16_bf16 v[64:79], v[200:203], v[204:207], v[64:79]
    s_waitcnt lgkmcnt(0)
    s_barrier
    s_nop 15
    s_nop 15
    v_lshlrev_b32 v18, 16, v18
    v_lshlrev_b32 v19, 16, v19
    v_cvt_pk_bf16_f32 v130, v64, v64
    v_lshlrev_b32 v130, 16, v130
    v_add_f32 v130, v130, v18
    v_cvt_pk_bf16_f32 v130, v130, v130
    v_lshlrev_b32 v130, 16, v130
    v_mul_f32 v131, 0xbfb8aa3b, v130
    v_exp_f32 v131, v131
    s_nop 0
    v_add_f32 v131, 1.0, v131
    v_rcp_f32 v132, v131
    s_nop 0
    v_mul_f32 v133, v130, v132
    v_fma_f32 v134, -v133, v131, v130
    v_fma_f32 v133, v134, v132, v133
    v_cvt_pk_bf16_f32 v133, v133, v133
    v_lshlrev_b32 v133, 16, v133
    v_lshlrev_b32 v134, 16, v32
    v_mul_f32 v134, v134, v19
    v_cvt_pk_bf16_f32 v134, v134, v134
    v_lshlrev_b32 v134, 16, v134
    v_lshlrev_b32 v135, 16, v24
    v_add_f32 v134, v134, v135
    v_cvt_pk_bf16_f32 v134, v134, v134
    v_lshlrev_b32 v134, 16, v134
    v_mul_f32 v134, v134, v133
    v_cvt_pk_bf16_f32 v134, v134, v134
    v_lshlrev_b32 v134, 16, v134
    v_lshlrev_b32 v135, 16, v48
    v_add_f32 v134, v134, v135
    v_cvt_pk_bf16_f32 v64, v134, v134
    s_mov_b32 s29, 0
    buffer_store_short v64, v22, s[44:47], s29 offen
    v_cvt_pk_bf16_f32 v130, v65, v65
    v_lshlrev_b32 v130, 16, v130
    v_add_f32 v130, v130, v18
    v_cvt_pk_bf16_f32 v130, v130, v130
    v_lshlrev_b32 v130, 16, v130
    v_mul_f32 v131, 0xbfb8aa3b, v130
    v_exp_f32 v131, v131
    s_nop 0
    v_add_f32 v131, 1.0, v131
    v_rcp_f32 v132, v131
    s_nop 0
    v_mul_f32 v133, v130, v132
    v_fma_f32 v134, -v133, v131, v130
    v_fma_f32 v133, v134, v132, v133
    v_cvt_pk_bf16_f32 v133, v133, v133
    v_lshlrev_b32 v133, 16, v133
    v_lshlrev_b32 v134, 16, v33
    v_mul_f32 v134, v134, v19
    v_cvt_pk_bf16_f32 v134, v134, v134
    v_lshlrev_b32 v134, 16, v134
    v_and_b32 v135, 0xffff0000, v24
    v_add_f32 v134, v134, v135
    v_cvt_pk_bf16_f32 v134, v134, v134
    v_lshlrev_b32 v134, 16, v134
    v_mul_f32 v134, v134, v133
    v_cvt_pk_bf16_f32 v134, v134, v134
    v_lshlrev_b32 v134, 16, v134
    v_lshlrev_b32 v135, 16, v49
    v_add_f32 v134, v134, v135
    v_cvt_pk_bf16_f32 v65, v134, v134
    s_mov_b32 s29, 896
    buffer_store_short v65, v22, s[44:47], s29 offen
    v_cvt_pk_bf16_f32 v130, v66, v66
    v_lshlrev_b32 v130, 16, v130
    v_add_f32 v130, v130, v18
    v_cvt_pk_bf16_f32 v130, v130, v130
    v_lshlrev_b32 v130, 16, v130
    v_mul_f32 v131, 0xbfb8aa3b, v130
    v_exp_f32 v131, v131
    s_nop 0
    v_add_f32 v131, 1.0, v131
    v_rcp_f32 v132, v131
    s_nop 0
    v_mul_f32 v133, v130, v132
    v_fma_f32 v134, -v133, v131, v130
    v_fma_f32 v133, v134, v132, v133
    v_cvt_pk_bf16_f32 v133, v133, v133
    v_lshlrev_b32 v133, 16, v133
    v_lshlrev_b32 v134, 16, v34
    v_mul_f32 v134, v134, v19
    v_cvt_pk_bf16_f32 v134, v134, v134
    v_lshlrev_b32 v134, 16, v134
    v_lshlrev_b32 v135, 16, v25
    v_add_f32 v134, v134, v135
    v_cvt_pk_bf16_f32 v134, v134, v134
    v_lshlrev_b32 v134, 16, v134
    v_mul_f32 v134, v134, v133
    v_cvt_pk_bf16_f32 v134, v134, v134
    v_lshlrev_b32 v134, 16, v134
    v_lshlrev_b32 v135, 16, v50
    v_add_f32 v134, v134, v135
    v_cvt_pk_bf16_f32 v66, v134, v134
    s_mov_b32 s29, 1792
    buffer_store_short v66, v22, s[44:47], s29 offen
    v_cvt_pk_bf16_f32 v130, v67, v67
    v_lshlrev_b32 v130, 16, v130
    v_add_f32 v130, v130, v18
    v_cvt_pk_bf16_f32 v130, v130, v130
    v_lshlrev_b32 v130, 16, v130
    v_mul_f32 v131, 0xbfb8aa3b, v130
    v_exp_f32 v131, v131
    s_nop 0
    v_add_f32 v131, 1.0, v131
    v_rcp_f32 v132, v131
    s_nop 0
    v_mul_f32 v133, v130, v132
    v_fma_f32 v134, -v133, v131, v130
    v_fma_f32 v133, v134, v132, v133
    v_cvt_pk_bf16_f32 v133, v133, v133
    v_lshlrev_b32 v133, 16, v133
    v_lshlrev_b32 v134, 16, v35
    v_mul_f32 v134, v134, v19
    v_cvt_pk_bf16_f32 v134, v134, v134
    v_lshlrev_b32 v134, 16, v134
    v_and_b32 v135, 0xffff0000, v25
    v_add_f32 v134, v134, v135
    v_cvt_pk_bf16_f32 v134, v134, v134
    v_lshlrev_b32 v134, 16, v134
    v_mul_f32 v134, v134, v133
    v_cvt_pk_bf16_f32 v134, v134, v134
    v_lshlrev_b32 v134, 16, v134
    v_lshlrev_b32 v135, 16, v51
    v_add_f32 v134, v134, v135
    v_cvt_pk_bf16_f32 v67, v134, v134
    s_mov_b32 s29, 2688
    buffer_store_short v67, v22, s[44:47], s29 offen
    v_cvt_pk_bf16_f32 v130, v68, v68
    v_lshlrev_b32 v130, 16, v130
    v_add_f32 v130, v130, v18
    v_cvt_pk_bf16_f32 v130, v130, v130
    v_lshlrev_b32 v130, 16, v130
    v_mul_f32 v131, 0xbfb8aa3b, v130
    v_exp_f32 v131, v131
    s_nop 0
    v_add_f32 v131, 1.0, v131
    v_rcp_f32 v132, v131
    s_nop 0
    v_mul_f32 v133, v130, v132
    v_fma_f32 v134, -v133, v131, v130
    v_fma_f32 v133, v134, v132, v133
    v_cvt_pk_bf16_f32 v133, v133, v133
    v_lshlrev_b32 v133, 16, v133
    v_lshlrev_b32 v134, 16, v36
    v_mul_f32 v134, v134, v19
    v_cvt_pk_bf16_f32 v134, v134, v134
    v_lshlrev_b32 v134, 16, v134
    v_lshlrev_b32 v135, 16, v26
    v_add_f32 v134, v134, v135
    v_cvt_pk_bf16_f32 v134, v134, v134
    v_lshlrev_b32 v134, 16, v134
    v_mul_f32 v134, v134, v133
    v_cvt_pk_bf16_f32 v134, v134, v134
    v_lshlrev_b32 v134, 16, v134
    v_lshlrev_b32 v135, 16, v52
    v_add_f32 v134, v134, v135
    v_cvt_pk_bf16_f32 v68, v134, v134
    s_mov_b32 s29, 7168
    buffer_store_short v68, v22, s[44:47], s29 offen
    v_cvt_pk_bf16_f32 v130, v69, v69
    v_lshlrev_b32 v130, 16, v130
    v_add_f32 v130, v130, v18
    v_cvt_pk_bf16_f32 v130, v130, v130
    v_lshlrev_b32 v130, 16, v130
    v_mul_f32 v131, 0xbfb8aa3b, v130
    v_exp_f32 v131, v131
    s_nop 0
    v_add_f32 v131, 1.0, v131
    v_rcp_f32 v132, v131
    s_nop 0
    v_mul_f32 v133, v130, v132
    v_fma_f32 v134, -v133, v131, v130
    v_fma_f32 v133, v134, v132, v133
    v_cvt_pk_bf16_f32 v133, v133, v133
    v_lshlrev_b32 v133, 16, v133
    v_lshlrev_b32 v134, 16, v37
    v_mul_f32 v134, v134, v19
    v_cvt_pk_bf16_f32 v134, v134, v134
    v_lshlrev_b32 v134, 16, v134
    v_and_b32 v135, 0xffff0000, v26
    v_add_f32 v134, v134, v135
    v_cvt_pk_bf16_f32 v134, v134, v134
    v_lshlrev_b32 v134, 16, v134
    v_mul_f32 v134, v134, v133
    v_cvt_pk_bf16_f32 v134, v134, v134
    v_lshlrev_b32 v134, 16, v134
    v_lshlrev_b32 v135, 16, v53
    v_add_f32 v134, v134, v135
    v_cvt_pk_bf16_f32 v69, v134, v134
    s_mov_b32 s29, 8064
    buffer_store_short v69, v22, s[44:47], s29 offen
    v_cvt_pk_bf16_f32 v130, v70, v70
    v_lshlrev_b32 v130, 16, v130
    v_add_f32 v130, v130, v18
    v_cvt_pk_bf16_f32 v130, v130, v130
    v_lshlrev_b32 v130, 16, v130
    v_mul_f32 v131, 0xbfb8aa3b, v130
    v_exp_f32 v131, v131
    s_nop 0
    v_add_f32 v131, 1.0, v131
    v_rcp_f32 v132, v131
    s_nop 0
    v_mul_f32 v133, v130, v132
    v_fma_f32 v134, -v133, v131, v130
    v_fma_f32 v133, v134, v132, v133
    v_cvt_pk_bf16_f32 v133, v133, v133
    v_lshlrev_b32 v133, 16, v133
    v_lshlrev_b32 v134, 16, v38
    v_mul_f32 v134, v134, v19
    v_cvt_pk_bf16_f32 v134, v134, v134
    v_lshlrev_b32 v134, 16, v134
    v_lshlrev_b32 v135, 16, v27
    v_add_f32 v134, v134, v135
    v_cvt_pk_bf16_f32 v134, v134, v134
    v_lshlrev_b32 v134, 16, v134
    v_mul_f32 v134, v134, v133
    v_cvt_pk_bf16_f32 v134, v134, v134
    v_lshlrev_b32 v134, 16, v134
    v_lshlrev_b32 v135, 16, v54
    v_add_f32 v134, v134, v135
    v_cvt_pk_bf16_f32 v70, v134, v134
    s_mov_b32 s29, 8960
    buffer_store_short v70, v22, s[44:47], s29 offen
    v_cvt_pk_bf16_f32 v130, v71, v71
    v_lshlrev_b32 v130, 16, v130
    v_add_f32 v130, v130, v18
    v_cvt_pk_bf16_f32 v130, v130, v130
    v_lshlrev_b32 v130, 16, v130
    v_mul_f32 v131, 0xbfb8aa3b, v130
    v_exp_f32 v131, v131
    s_nop 0
    v_add_f32 v131, 1.0, v131
    v_rcp_f32 v132, v131
    s_nop 0
    v_mul_f32 v133, v130, v132
    v_fma_f32 v134, -v133, v131, v130
    v_fma_f32 v133, v134, v132, v133
    v_cvt_pk_bf16_f32 v133, v133, v133
    v_lshlrev_b32 v133, 16, v133
    v_lshlrev_b32 v134, 16, v39
    v_mul_f32 v134, v134, v19
    v_cvt_pk_bf16_f32 v134, v134, v134
    v_lshlrev_b32 v134, 16, v134
    v_and_b32 v135, 0xffff0000, v27
    v_add_f32 v134, v134, v135
    v_cvt_pk_bf16_f32 v134, v134, v134
    v_lshlrev_b32 v134, 16, v134
    v_mul_f32 v134, v134, v133
    v_cvt_pk_bf16_f32 v134, v134, v134
    v_lshlrev_b32 v134, 16, v134
    v_lshlrev_b32 v135, 16, v55
    v_add_f32 v134, v134, v135
    v_cvt_pk_bf16_f32 v71, v134, v134
    s_mov_b32 s29, 9856
    buffer_store_short v71, v22, s[44:47], s29 offen
    v_cvt_pk_bf16_f32 v130, v72, v72
    v_lshlrev_b32 v130, 16, v130
    v_add_f32 v130, v130, v18
    v_cvt_pk_bf16_f32 v130, v130, v130
    v_lshlrev_b32 v130, 16, v130
    v_mul_f32 v131, 0xbfb8aa3b, v130
    v_exp_f32 v131, v131
    s_nop 0
    v_add_f32 v131, 1.0, v131
    v_rcp_f32 v132, v131
    s_nop 0
    v_mul_f32 v133, v130, v132
    v_fma_f32 v134, -v133, v131, v130
    v_fma_f32 v133, v134, v132, v133
    v_cvt_pk_bf16_f32 v133, v133, v133
    v_lshlrev_b32 v133, 16, v133
    v_lshlrev_b32 v134, 16, v40
    v_mul_f32 v134, v134, v19
    v_cvt_pk_bf16_f32 v134, v134, v134
    v_lshlrev_b32 v134, 16, v134
    v_lshlrev_b32 v135, 16, v28
    v_add_f32 v134, v134, v135
    v_cvt_pk_bf16_f32 v134, v134, v134
    v_lshlrev_b32 v134, 16, v134
    v_mul_f32 v134, v134, v133
    v_cvt_pk_bf16_f32 v134, v134, v134
    v_lshlrev_b32 v134, 16, v134
    v_lshlrev_b32 v135, 16, v56
    v_add_f32 v134, v134, v135
    v_cvt_pk_bf16_f32 v72, v134, v134
    s_mov_b32 s29, 14336
    buffer_store_short v72, v22, s[44:47], s29 offen
    v_cvt_pk_bf16_f32 v130, v73, v73
    v_lshlrev_b32 v130, 16, v130
    v_add_f32 v130, v130, v18
    v_cvt_pk_bf16_f32 v130, v130, v130
    v_lshlrev_b32 v130, 16, v130
    v_mul_f32 v131, 0xbfb8aa3b, v130
    v_exp_f32 v131, v131
    s_nop 0
    v_add_f32 v131, 1.0, v131
    v_rcp_f32 v132, v131
    s_nop 0
    v_mul_f32 v133, v130, v132
    v_fma_f32 v134, -v133, v131, v130
    v_fma_f32 v133, v134, v132, v133
    v_cvt_pk_bf16_f32 v133, v133, v133
    v_lshlrev_b32 v133, 16, v133
    v_lshlrev_b32 v134, 16, v41
    v_mul_f32 v134, v134, v19
    v_cvt_pk_bf16_f32 v134, v134, v134
    v_lshlrev_b32 v134, 16, v134
    v_and_b32 v135, 0xffff0000, v28
    v_add_f32 v134, v134, v135
    v_cvt_pk_bf16_f32 v134, v134, v134
    v_lshlrev_b32 v134, 16, v134
    v_mul_f32 v134, v134, v133
    v_cvt_pk_bf16_f32 v134, v134, v134
    v_lshlrev_b32 v134, 16, v134
    v_lshlrev_b32 v135, 16, v57
    v_add_f32 v134, v134, v135
    v_cvt_pk_bf16_f32 v73, v134, v134
    s_mov_b32 s29, 15232
    buffer_store_short v73, v22, s[44:47], s29 offen
    v_cvt_pk_bf16_f32 v130, v74, v74
    v_lshlrev_b32 v130, 16, v130
    v_add_f32 v130, v130, v18
    v_cvt_pk_bf16_f32 v130, v130, v130
    v_lshlrev_b32 v130, 16, v130
    v_mul_f32 v131, 0xbfb8aa3b, v130
    v_exp_f32 v131, v131
    s_nop 0
    v_add_f32 v131, 1.0, v131
    v_rcp_f32 v132, v131
    s_nop 0
    v_mul_f32 v133, v130, v132
    v_fma_f32 v134, -v133, v131, v130
    v_fma_f32 v133, v134, v132, v133
    v_cvt_pk_bf16_f32 v133, v133, v133
    v_lshlrev_b32 v133, 16, v133
    v_lshlrev_b32 v134, 16, v42
    v_mul_f32 v134, v134, v19
    v_cvt_pk_bf16_f32 v134, v134, v134
    v_lshlrev_b32 v134, 16, v134
    v_lshlrev_b32 v135, 16, v29
    v_add_f32 v134, v134, v135
    v_cvt_pk_bf16_f32 v134, v134, v134
    v_lshlrev_b32 v134, 16, v134
    v_mul_f32 v134, v134, v133
    v_cvt_pk_bf16_f32 v134, v134, v134
    v_lshlrev_b32 v134, 16, v134
    v_lshlrev_b32 v135, 16, v58
    v_add_f32 v134, v134, v135
    v_cvt_pk_bf16_f32 v74, v134, v134
    s_mov_b32 s29, 16128
    buffer_store_short v74, v22, s[44:47], s29 offen
    v_cvt_pk_bf16_f32 v130, v75, v75
    v_lshlrev_b32 v130, 16, v130
    v_add_f32 v130, v130, v18
    v_cvt_pk_bf16_f32 v130, v130, v130
    v_lshlrev_b32 v130, 16, v130
    v_mul_f32 v131, 0xbfb8aa3b, v130
    v_exp_f32 v131, v131
    s_nop 0
    v_add_f32 v131, 1.0, v131
    v_rcp_f32 v132, v131
    s_nop 0
    v_mul_f32 v133, v130, v132
    v_fma_f32 v134, -v133, v131, v130
    v_fma_f32 v133, v134, v132, v133
    v_cvt_pk_bf16_f32 v133, v133, v133
    v_lshlrev_b32 v133, 16, v133
    v_lshlrev_b32 v134, 16, v43
    v_mul_f32 v134, v134, v19
    v_cvt_pk_bf16_f32 v134, v134, v134
    v_lshlrev_b32 v134, 16, v134
    v_and_b32 v135, 0xffff0000, v29
    v_add_f32 v134, v134, v135
    v_cvt_pk_bf16_f32 v134, v134, v134
    v_lshlrev_b32 v134, 16, v134
    v_mul_f32 v134, v134, v133
    v_cvt_pk_bf16_f32 v134, v134, v134
    v_lshlrev_b32 v134, 16, v134
    v_lshlrev_b32 v135, 16, v59
    v_add_f32 v134, v134, v135
    v_cvt_pk_bf16_f32 v75, v134, v134
    s_mov_b32 s29, 17024
    buffer_store_short v75, v22, s[44:47], s29 offen
    v_cvt_pk_bf16_f32 v130, v76, v76
    v_lshlrev_b32 v130, 16, v130
    v_add_f32 v130, v130, v18
    v_cvt_pk_bf16_f32 v130, v130, v130
    v_lshlrev_b32 v130, 16, v130
    v_mul_f32 v131, 0xbfb8aa3b, v130
    v_exp_f32 v131, v131
    s_nop 0
    v_add_f32 v131, 1.0, v131
    v_rcp_f32 v132, v131
    s_nop 0
    v_mul_f32 v133, v130, v132
    v_fma_f32 v134, -v133, v131, v130
    v_fma_f32 v133, v134, v132, v133
    v_cvt_pk_bf16_f32 v133, v133, v133
    v_lshlrev_b32 v133, 16, v133
    v_lshlrev_b32 v134, 16, v44
    v_mul_f32 v134, v134, v19
    v_cvt_pk_bf16_f32 v134, v134, v134
    v_lshlrev_b32 v134, 16, v134
    v_lshlrev_b32 v135, 16, v30
    v_add_f32 v134, v134, v135
    v_cvt_pk_bf16_f32 v134, v134, v134
    v_lshlrev_b32 v134, 16, v134
    v_mul_f32 v134, v134, v133
    v_cvt_pk_bf16_f32 v134, v134, v134
    v_lshlrev_b32 v134, 16, v134
    v_lshlrev_b32 v135, 16, v60
    v_add_f32 v134, v134, v135
    v_cvt_pk_bf16_f32 v76, v134, v134
    s_mov_b32 s29, 21504
    buffer_store_short v76, v22, s[44:47], s29 offen
    v_cvt_pk_bf16_f32 v130, v77, v77
    v_lshlrev_b32 v130, 16, v130
    v_add_f32 v130, v130, v18
    v_cvt_pk_bf16_f32 v130, v130, v130
    v_lshlrev_b32 v130, 16, v130
    v_mul_f32 v131, 0xbfb8aa3b, v130
    v_exp_f32 v131, v131
    s_nop 0
    v_add_f32 v131, 1.0, v131
    v_rcp_f32 v132, v131
    s_nop 0
    v_mul_f32 v133, v130, v132
    v_fma_f32 v134, -v133, v131, v130
    v_fma_f32 v133, v134, v132, v133
    v_cvt_pk_bf16_f32 v133, v133, v133
    v_lshlrev_b32 v133, 16, v133
    v_lshlrev_b32 v134, 16, v45
    v_mul_f32 v134, v134, v19
    v_cvt_pk_bf16_f32 v134, v134, v134
    v_lshlrev_b32 v134, 16, v134
    v_and_b32 v135, 0xffff0000, v30
    v_add_f32 v134, v134, v135
    v_cvt_pk_bf16_f32 v134, v134, v134
    v_lshlrev_b32 v134, 16, v134
    v_mul_f32 v134, v134, v133
    v_cvt_pk_bf16_f32 v134, v134, v134
    v_lshlrev_b32 v134, 16, v134
    v_lshlrev_b32 v135, 16, v61
    v_add_f32 v134, v134, v135
    v_cvt_pk_bf16_f32 v77, v134, v134
    s_mov_b32 s29, 22400
    buffer_store_short v77, v22, s[44:47], s29 offen
    v_cvt_pk_bf16_f32 v130, v78, v78
    v_lshlrev_b32 v130, 16, v130
    v_add_f32 v130, v130, v18
    v_cvt_pk_bf16_f32 v130, v130, v130
    v_lshlrev_b32 v130, 16, v130
    v_mul_f32 v131, 0xbfb8aa3b, v130
    v_exp_f32 v131, v131
    s_nop 0
    v_add_f32 v131, 1.0, v131
    v_rcp_f32 v132, v131
    s_nop 0
    v_mul_f32 v133, v130, v132
    v_fma_f32 v134, -v133, v131, v130
    v_fma_f32 v133, v134, v132, v133
    v_cvt_pk_bf16_f32 v133, v133, v133
    v_lshlrev_b32 v133, 16, v133
    v_lshlrev_b32 v134, 16, v46
    v_mul_f32 v134, v134, v19
    v_cvt_pk_bf16_f32 v134, v134, v134
    v_lshlrev_b32 v134, 16, v134
    v_lshlrev_b32 v135, 16, v31
    v_add_f32 v134, v134, v135
    v_cvt_pk_bf16_f32 v134, v134, v134
    v_lshlrev_b32 v134, 16, v134
    v_mul_f32 v134, v134, v133
    v_cvt_pk_bf16_f32 v134, v134, v134
    v_lshlrev_b32 v134, 16, v134
    v_lshlrev_b32 v135, 16, v62
    v_add_f32 v134, v134, v135
    v_cvt_pk_bf16_f32 v78, v134, v134
    s_mov_b32 s29, 23296
    buffer_store_short v78, v22, s[44:47], s29 offen
    v_cvt_pk_bf16_f32 v130, v79, v79
    v_lshlrev_b32 v130, 16, v130
    v_add_f32 v130, v130, v18
    v_cvt_pk_bf16_f32 v130, v130, v130
    v_lshlrev_b32 v130, 16, v130
    v_mul_f32 v131, 0xbfb8aa3b, v130
    v_exp_f32 v131, v131
    s_nop 0
    v_add_f32 v131, 1.0, v131
    v_rcp_f32 v132, v131
    s_nop 0
    v_mul_f32 v133, v130, v132
    v_fma_f32 v134, -v133, v131, v130
    v_fma_f32 v133, v134, v132, v133
    v_cvt_pk_bf16_f32 v133, v133, v133
    v_lshlrev_b32 v133, 16, v133
    v_lshlrev_b32 v134, 16, v47
    v_mul_f32 v134, v134, v19
    v_cvt_pk_bf16_f32 v134, v134, v134
    v_lshlrev_b32 v134, 16, v134
    v_and_b32 v135, 0xffff0000, v31
    v_add_f32 v134, v134, v135
    v_cvt_pk_bf16_f32 v134, v134, v134
    v_lshlrev_b32 v134, 16, v134
    v_mul_f32 v134, v134, v133
    v_cvt_pk_bf16_f32 v134, v134, v134
    v_lshlrev_b32 v134, 16, v134
    v_lshlrev_b32 v135, 16, v63
    v_add_f32 v134, v134, v135
    v_cvt_pk_bf16_f32 v79, v134, v134
    s_mov_b32 s29, 24192
    buffer_store_short v79, v22, s[44:47], s29 offen
L_g2_end:
    s_endpgm
.section .rodata,"a"
.p2align 6
.amdhsa_kernel prep_kernel
  .amdhsa_next_free_vgpr 136
  .amdhsa_next_free_sgpr 102
  .amdhsa_accum_offset 136
  .amdhsa_group_segment_fixed_size 0
  .amdhsa_kernarg_size 120
  .amdhsa_user_sgpr_count 2
  .amdhsa_user_sgpr_kernarg_segment_ptr 1
  .amdhsa_system_sgpr_workgroup_id_x 1
.end_amdhsa_kernel
.section .rodata,"a"
.p2align 6
.amdhsa_kernel mid_kernel
  .amdhsa_next_free_vgpr 256
  .amdhsa_next_free_sgpr 102
  .amdhsa_accum_offset 256
  .amdhsa_group_segment_fixed_size 0
  .amdhsa_kernarg_size 120
  .amdhsa_user_sgpr_count 2
  .amdhsa_user_sgpr_kernarg_segment_ptr 1
  .amdhsa_system_sgpr_workgroup_id_x 1
.end_amdhsa_kernel
.section .rodata,"a"
.p2align 6
.amdhsa_kernel gemm2_kernel
  .amdhsa_next_free_vgpr 256
  .amdhsa_next_free_sgpr 102
  .amdhsa_accum_offset 256
  .amdhsa_group_segment_fixed_size 0
  .amdhsa_kernarg_size 120
  .amdhsa_user_sgpr_count 2
  .amdhsa_user_sgpr_kernarg_segment_ptr 1
  .amdhsa_system_sgpr_workgroup_id_x 1
.end_amdhsa_kernel
```
